```python
import torch

def _softmax(x, axis=-1):
    return torch.softmax(x, dim=axis)
def _gelu(x):
    return torch.nn.functional.gelu(x, approximate="tanh")
def _silu(x):
    return torch.nn.functional.silu(x)
def _sigmoid(x):
    return torch.sigmoid(x)
def _layernorm(x, axis=-1, eps=1e-5):
    m = x.mean(dim=axis, keepdim=True)
    v = x.var(dim=axis, keepdim=True, unbiased=False)
    return (x - m) / torch.sqrt(v + eps)
def _scatter_add(tgt, idx, src, axis=0):
    return tgt.clone().index_add_(axis, idx, src)
def _segment_sum(src, seg, n):
    out = torch.zeros((n,) + src.shape[1:], dtype=src.dtype)
    return out.index_add_(0, seg, src)
def _pad(x, pw):
    flat = tuple(v for pair in reversed(pw) for v in pair)
    return torch.nn.functional.pad(x, flat)

kernel_name = 'parallel_sum__ssm_conv_s4__glu_gated_bilinear__prompt'

def setup_inputs():

    _w = (lambda a: (lambda t: t.to(torch.bfloat16) if t.is_floating_point() else t)(torch.as_tensor(a)))
    def _A_setup():
        B, L, D, N = 1, 2048, 448, 256
        A_re = -(lambda _x: torch.exp(torch.as_tensor(_x)))((lambda *s: torch.randn(*s, dtype=torch.bfloat16) * 6.4)(D, N))
        A_im = torch.pi * (lambda *s: torch.randn(*s, dtype=torch.bfloat16) * 0.05)(D, N)
        B_re = (lambda *s: torch.randn(*s, dtype=torch.bfloat16) * 0.1)(D, N)
        B_im = (lambda *s: torch.randn(*s, dtype=torch.bfloat16) * 0.1)(D, N)
        C_re = (lambda *s: torch.randn(*s, dtype=torch.bfloat16) * 0.1)(D, N)
        C_im = (lambda *s: torch.randn(*s, dtype=torch.bfloat16) * 0.1)(D, N)
        log_dt = (lambda *s: torch.randn(*s, dtype=torch.bfloat16) * 0.05)(D) * 0.5 - 4.0
        Dskip = (lambda *s: torch.randn(*s, dtype=torch.bfloat16) * 0.05)(D)
        return {
            "u": _w((lambda *s: torch.randn(*s, dtype=torch.bfloat16) * 0.05)(B, L, D)),
            "A_re": _w(A_re),
            "A_im": _w(A_im),
            "B_re": _w(B_re),
            "B_im": _w(B_im),
            "C_re": _w(C_re),
            "C_im": _w(C_im),
            "log_dt": _w(log_dt),
            "Dskip": _w(Dskip),
        }
    _A_in = _A_setup()

    def _B_setup():
        B, S, D, F = 1, 2048, 448, 1792
        return {
            "x": _w((lambda *s: torch.randn(*s, dtype=torch.bfloat16) * 0.05)(B, S, D)),
            "w_gate": _w((lambda *s: torch.randn(*s, dtype=torch.bfloat16) * 0.4)(D, F) * (D ** -0.5)),
            "w_up": _w((lambda *s: torch.randn(*s, dtype=torch.bfloat16) * 0.4)(D, F) * (D ** -0.5)),
            "w_down": _w((lambda *s: torch.randn(*s, dtype=torch.bfloat16) * 0.4)(F, D) * (F ** -0.5)),
        }
    _B_in = _B_setup()

    return {
        "A_u": _A_in["u"],
        "A_A_re": _A_in["A_re"],
        "A_A_im": _A_in["A_im"],
        "A_B_re": _A_in["B_re"],
        "A_B_im": _A_in["B_im"],
        "A_C_re": _A_in["C_re"],
        "A_C_im": _A_in["C_im"],
        "A_log_dt": _A_in["log_dt"],
        "A_Dskip": _A_in["Dskip"],
        "B_x": _B_in["x"],
        "B_w_gate": _B_in["w_gate"],
        "B_w_up": _B_in["w_up"],
        "B_w_down": _B_in["w_down"],
    }

def reference(A_u, A_A_re, A_A_im, A_B_re, A_B_im, A_C_re, A_C_im, A_log_dt, A_Dskip, B_x, B_w_gate, B_w_up, B_w_down):
    def _A_ref(u, A_re, A_im, B_re, B_im, C_re, C_im, log_dt, Dskip):
        Bsz, L, D = u.shape
        dt = torch.exp(log_dt)[:, None]
        A = A_re + 1j * A_im
        Bc = B_re + 1j * B_im
        Cc = C_re + 1j * C_im
        logdA = dt * A
        dB = dt * Bc
        l = (lambda x, dt: x.to(dt))(torch.arange(L), A_re.dtype)
        P = torch.exp(logdA[:, :, None] * l[None, None, :])
        K = torch.einsum("dn,dnl,dn->dl", Cc, P, dB).real
        L2 = 2 * L
        Kp = _pad(K, ((0, 0), (0, L)))
        up = (lambda x, *d: x.permute(*d))(u, 0, 2, 1)
        up = _pad(up, ((0, 0), (0, 0), (0, L)))
        Kf = (lambda x, axes=(-2,-1): torch.fft.rfft2(x.float(), dim=axes))(Kp[:, None, :], axes=(-2, -1))
        Uf = (lambda x, axes=(-2,-1): torch.fft.rfft2(x.float(), dim=axes))(up[:, :, None, :], axes=(-2, -1))
        Yf = Uf * Kf[None, :, :, :]
        y = (lambda x, s, axes=(-2,-1): torch.fft.irfft2(x, s=s, dim=axes).to(torch.bfloat16))(Yf, (1, L2), axes=(-2, -1))[:, :, 0, :L]
        y = (lambda x, *d: x.permute(*d))(y, 0, 2, 1) + u * Dskip[None, None, :]
        return y

    def _B_ref(x, w_gate, w_up, w_down):
        g = torch.einsum("bsd,df->bsf", x, w_gate)
        u = torch.einsum("bsd,df->bsf", x, w_up)
        h = g * u
        return torch.einsum("bsf,fd->bsd", h, w_down)

    x = A_u
    xn = _layernorm(x, axis=-1)
    return x + _A_ref(xn, A_A_re, A_A_im, A_B_re, A_B_im, A_C_re, A_C_im, A_log_dt, A_Dskip) + _B_ref(xn, B_w_gate, B_w_up, B_w_down)
```

```asm
; @launch grid=(256,1,1) block=(512,1,1) lds=162560
.amdgcn_target "amdgcn-amd-amdhsa--gfx950"
.text
.globl parallel_sum__ssm_conv_s4__glu_gated_bilinear__prompt_kernel
.p2align 8
.type parallel_sum__ssm_conv_s4__glu_gated_bilinear__prompt_kernel,@function
parallel_sum__ssm_conv_s4__glu_gated_bilinear__prompt_kernel:
    s_cmp_ge_u32 s2, 256
    s_cbranch_scc1 L_END
    s_load_dwordx16 s[16:31], s[0:1], 0
    s_load_dwordx16 s[32:47], s[0:1], 64
    v_lshrrev_b32 v2, 6, v0
    v_and_b32 v1, 63, v0
    v_readfirstlane_b32 s3, v2
    s_waitcnt lgkmcnt(0)
    s_getpc_b64 s[80:81]
    s_and_b32 s80, s80, 0xffffff00
    v_lshlrev_b32 v2, 7, v0
    v_min_u32 v2, L_CODE_END-parallel_sum__ssm_conv_s4__glu_gated_bilinear__prompt_kernel-4, v2
    global_load_dword v127, v2, s[80:81]
    s_mov_b32 s48, s16
    s_mov_b32 s49, s17
    s_mov_b32 s50, 1835008
    s_mov_b32 s51, 0x00020000
    s_mov_b32 s52, s46
    s_mov_b32 s53, s47
    s_mov_b32 s54, 1835008
    s_mov_b32 s55, 0x00020000
    s_add_u32 s56, s46, 2097152
    s_addc_u32 s57, s47, 0
    s_mov_b32 s58, 1835008
    s_mov_b32 s59, 0x00020000
    s_mov_b32 s60, s44
    s_mov_b32 s61, s45
    s_mov_b32 s62, 256
    s_mov_b32 s63, 0x00020000
    s_add_u32 s8, s46, 16777216
    s_addc_u32 s9, s47, 0
    s_mov_b32 s10, 163840
    s_mov_b32 s11, 0x00020000
    s_mov_b32 s12, 0
    s_mov_b32 s13, 0
    s_cmp_lg_u32 s2, 0
    s_cbranch_scc1 L_NONP
    s_cmp_lg_u32 s3, 7
    s_cbranch_scc1 L_NONP
    s_memrealtime s[80:81]
    s_waitcnt lgkmcnt(0)
    s_or_b32 s80, s80, 1
    v_mov_b32 v2, 0
    v_mov_b32 v4, s80
    v_mov_b32 v5, s81
    s_mov_b64 exec, 1
    buffer_store_dwordx2 v[4:5], v2, s[60:63], 0 offen sc0 sc1
    s_mov_b64 exec, -1
L_NONP:
    v_mov_b32 v2, 152192
    v_mov_b32 v4, 0
    v_mov_b32 v5, 0
    v_mov_b32 v6, 0
    v_mov_b32 v7, 0
    ds_write_b128 v2, v[4:7]
    ds_write_b128 v2, v[4:7] offset:16
    ds_write_b128 v2, v[4:7] offset:32
    ds_write_b128 v2, v[4:7] offset:48
    ds_write_b128 v2, v[4:7] offset:64
    ds_write_b128 v2, v[4:7] offset:80
    s_cmp_lt_u32 s3, 4
    s_cbranch_scc1 L_GPATH
    s_waitcnt lgkmcnt(0)
    s_barrier
    s_cmp_lt_u32 s2, 224
    s_cbranch_scc1 SX_1
    s_cmp_lg_u32 s3, 5
    s_cbranch_scc1 L_END
    v_mov_b32 v60, 0
NONCE_2:
    buffer_load_dwordx2 v[62:63], v60, s[60:63], 0 offen sc0 sc1
    s_waitcnt vmcnt(0)
    v_readfirstlane_b32 s12, v62
    v_readfirstlane_b32 s13, v63
    s_cmp_lg_u32 s12, 0
    s_cbranch_scc1 NONCE_2_ok
    s_sleep 4
    s_branch NONCE_2
NONCE_2_ok:
    v_mov_b32 v60, 152264
    ds_write_b64 v60, v[62:63]
    s_waitcnt lgkmcnt(0)
    s_branch L_END
SX_1:
    s_sub_u32 s87, s3, 4
    s_lshr_b32 s85, s87, 1
    s_lshl_b32 s84, s2, 1
    s_add_u32 s85, s85, s84
    s_and_b32 s86, s87, 1
    s_lshl_b32 s84, s85, 9
    s_lshl_b32 s88, s86, 8
    s_add_u32 s84, s84, s88
    v_lshlrev_b32 v98, 1, v1
    v_add_u32 v98, s84, v98
    s_lshl_b32 s84, s85, 1
    v_mov_b32 v99, s84
    global_load_ushort v100, v98, s[18:19]
    global_load_ushort v101, v98, s[18:19] offset:128
    global_load_ushort v102, v98, s[20:21]
    global_load_ushort v103, v98, s[20:21] offset:128
    global_load_ushort v104, v98, s[22:23]
    global_load_ushort v105, v98, s[22:23] offset:128
    global_load_ushort v106, v98, s[24:25]
    global_load_ushort v107, v98, s[24:25] offset:128
    global_load_ushort v108, v98, s[26:27]
    global_load_ushort v109, v98, s[26:27] offset:128
    global_load_ushort v110, v98, s[28:29]
    global_load_ushort v111, v98, s[28:29] offset:128
    global_load_ushort v112, v99, s[30:31]
    global_load_ushort v113, v99, s[32:33]
    s_cmp_lg_u32 s3, 5
    s_cbranch_scc1 NS_3
    v_mov_b32 v60, 0
NONCE_4:
    buffer_load_dwordx2 v[62:63], v60, s[60:63], 0 offen sc0 sc1
    s_waitcnt vmcnt(0)
    v_readfirstlane_b32 s12, v62
    v_readfirstlane_b32 s13, v63
    s_cmp_lg_u32 s12, 0
    s_cbranch_scc1 NONCE_4_ok
    s_sleep 4
    s_branch NONCE_4
NONCE_4_ok:
    v_mov_b32 v60, 152264
    ds_write_b64 v60, v[62:63]
NS_3:
    s_waitcnt vmcnt(0)
    v_lshlrev_b32 v100, 16, v100
    v_lshlrev_b32 v101, 16, v101
    v_lshlrev_b32 v102, 16, v102
    v_lshlrev_b32 v103, 16, v103
    v_lshlrev_b32 v104, 16, v104
    v_lshlrev_b32 v105, 16, v105
    v_lshlrev_b32 v106, 16, v106
    v_lshlrev_b32 v107, 16, v107
    v_lshlrev_b32 v108, 16, v108
    v_lshlrev_b32 v109, 16, v109
    v_lshlrev_b32 v110, 16, v110
    v_lshlrev_b32 v111, 16, v111
    v_lshlrev_b32 v112, 16, v112
    v_lshlrev_b32 v113, 16, v113
    v_mov_b32 v2, 1069066811
    v_mul_f32 v112, v112, v2
    v_exp_f32 v112, v112
    s_nop 0
    v_cvt_pk_bf16_f32 v112, v112, v112
    v_lshlrev_b32 v112, 16, v112
    s_mul_i32 s84, s87, 2560
    s_add_u32 s84, s84, 98304
    v_lshlrev_b32 v3, 2, v1
    v_add_u32 v3, s84, v3
    v_mov_b32 v4, 1042479491
    v_mov_b32 v5, 836541576
    v_mul_f32 v100, v112, v100
    v_mul_f32 v102, v112, v102
    v_mul_f32 v104, v112, v104
    v_mul_f32 v106, v112, v106
    v_mul_f32 v6, v100, v2
    v_mul_f32 v7, v102, v4
    v_fma_f32 v8, v102, v4, -v7
    v_fma_f32 v8, v102, v5, v8
    v_and_b32 v9, 0xffffff00, v7
    v_sub_f32 v7, v7, v9
    v_add_f32 v7, v7, v8
    v_mul_f32 v10, v108, v104
    v_fma_f32 v10, -v110, v106, v10
    v_mul_f32 v11, v108, v106
    v_fma_f32 v11, v110, v104, v11
    ds_write_b32 v3, v6 offset:0
    ds_write_b32 v3, v9 offset:512
    ds_write_b32 v3, v7 offset:1024
    ds_write_b32 v3, v10 offset:1536
    ds_write_b32 v3, v11 offset:2048
    v_mul_f32 v101, v112, v101
    v_mul_f32 v103, v112, v103
    v_mul_f32 v105, v112, v105
    v_mul_f32 v107, v112, v107
    v_mul_f32 v6, v101, v2
    v_mul_f32 v7, v103, v4
    v_fma_f32 v8, v103, v4, -v7
    v_fma_f32 v8, v103, v5, v8
    v_and_b32 v9, 0xffffff00, v7
    v_sub_f32 v7, v7, v9
    v_add_f32 v7, v7, v8
    v_mul_f32 v10, v109, v105
    v_fma_f32 v10, -v111, v107, v10
    v_mul_f32 v11, v109, v107
    v_fma_f32 v11, v111, v105, v11
    ds_write_b32 v3, v6 offset:256
    ds_write_b32 v3, v9 offset:768
    ds_write_b32 v3, v7 offset:1280
    ds_write_b32 v3, v10 offset:1792
    ds_write_b32 v3, v11 offset:2304
    s_and_b32 s92, s2, 7
    s_lshr_b32 s93, s2, 3
    s_mul_i32 s94, s93, 37
    s_lshr_b32 s94, s94, 8
    s_mul_i32 s95, s94, 7
    s_sub_u32 s95, s93, s95
    s_and_b32 s96, s92, 1
    s_mul_i32 s96, s96, 7
    s_add_u32 s96, s96, s95
    s_mul_i32 s97, s94, 112
    s_mul_i32 s98, s87, 28
    s_add_u32 s97, s97, s98
    v_lshrrev_b32 v6, 1, v1
    v_min_u32 v6, 27, v6
    v_add_u32 v6, s97, v6
    v_mul_u32_u24 v6, 3584, v6
    v_and_b32 v7, 1, v1
    v_lshl_add_u32 v6, v7, 7, v6
    s_lshl_b32 s97, s96, 8
    v_add_u32 v6, s97, v6
    global_load_dword v96, v6, s[36:37]
    global_load_dword v97, v6, s[38:39]
    s_lshr_b32 s84, s87, 1
    s_mul_i32 s84, s84, 2816
    s_add_u32 s84, s84, 124928
    s_cmp_eq_u32 s86, 0
    s_cselect_b64 vcc, -1, 0
    v_and_b32 v2, 31, v1
    v_lshlrev_b32 v2, 3, v2
    v_lshrrev_b32 v6, 5, v1
    v_cmp_eq_u32 s[92:93], 0, v6
    v_mov_b32 v32, 0
    v_mov_b32 v33, 512
    v_cndmask_b32 v32, v33, v32, vcc
    v_mov_b32 v33, 4
    v_mov_b32 v34, 4096
    v_cndmask_b32 v33, v34, v33, vcc
    v_cndmask_b32 v32, v33, v32, s[92:93]
    v_add_u32 v32, v32, v2
    v_cvt_f32_u32 v33, v32
    v_lshrrev_b32 v33, 16, v33
    v_subrev_u32 v33, 17024, v33
    v_mov_b32 v36, 1
    v_mov_b32 v37, 516
    v_cndmask_b32 v36, v37, v36, vcc
    v_mov_b32 v37, 5
    v_mov_b32 v38, 4096
    v_cndmask_b32 v37, v38, v37, vcc
    v_cndmask_b32 v36, v37, v36, s[92:93]
    v_add_u32 v36, v36, v2
    v_cvt_f32_u32 v37, v36
    v_lshrrev_b32 v37, 16, v37
    v_subrev_u32 v37, 17024, v37
    v_mov_b32 v40, 2
    v_mov_b32 v41, 768
    v_cndmask_b32 v40, v41, v40, vcc
    v_mov_b32 v41, 6
    v_mov_b32 v42, 4096
    v_cndmask_b32 v41, v42, v41, vcc
    v_cndmask_b32 v40, v41, v40, s[92:93]
    v_add_u32 v40, v40, v2
    v_cvt_f32_u32 v41, v40
    v_lshrrev_b32 v41, 16, v41
    v_subrev_u32 v41, 17024, v41
    v_mov_b32 v44, 3
    v_mov_b32 v45, 772
    v_cndmask_b32 v44, v45, v44, vcc
    v_mov_b32 v45, 7
    v_mov_b32 v46, 4096
    v_cndmask_b32 v45, v46, v45, vcc
    v_cndmask_b32 v44, v45, v44, s[92:93]
    v_add_u32 v44, v44, v2
    v_cvt_f32_u32 v45, v44
    v_lshrrev_b32 v45, 16, v45
    v_subrev_u32 v45, 17024, v45
    v_mov_b32 v48, 256
    v_mov_b32 v49, 1024
    v_cndmask_b32 v48, v49, v48, vcc
    v_mov_b32 v49, 4096
    v_mov_b32 v50, 2048
    v_cndmask_b32 v49, v50, v49, vcc
    v_cndmask_b32 v48, v49, v48, s[92:93]
    v_add_u32 v48, v48, v2
    v_cvt_f32_u32 v49, v48
    v_lshrrev_b32 v49, 16, v49
    v_subrev_u32 v49, 17024, v49
    v_mov_b32 v52, 258
    v_mov_b32 v53, 1280
    v_cndmask_b32 v52, v53, v52, vcc
    v_mov_b32 v53, 4096
    v_mov_b32 v54, 4096
    v_cndmask_b32 v53, v54, v53, vcc
    v_cndmask_b32 v52, v53, v52, s[92:93]
    v_add_u32 v52, v52, v2
    v_cvt_f32_u32 v53, v52
    v_lshrrev_b32 v53, 16, v53
    v_subrev_u32 v53, 17024, v53
    v_mov_b32 v56, 260
    v_mov_b32 v57, 1536
    v_cndmask_b32 v56, v57, v56, vcc
    v_mov_b32 v57, 4096
    v_mov_b32 v58, 4096
    v_cndmask_b32 v57, v58, v57, vcc
    v_cndmask_b32 v56, v57, v56, s[92:93]
    v_add_u32 v56, v56, v2
    v_cvt_f32_u32 v57, v56
    v_lshrrev_b32 v57, 16, v57
    v_subrev_u32 v57, 17024, v57
    v_mov_b32 v60, 262
    v_mov_b32 v61, 1792
    v_cndmask_b32 v60, v61, v60, vcc
    v_mov_b32 v61, 4096
    v_mov_b32 v62, 4096
    v_cndmask_b32 v61, v62, v61, vcc
    v_cndmask_b32 v60, v61, v60, s[92:93]
    v_add_u32 v60, v60, v2
    v_cvt_f32_u32 v61, v60
    v_lshrrev_b32 v61, 16, v61
    v_subrev_u32 v61, 17024, v61
    v_cmp_gt_u32 vcc, 256, v32
    s_nop 1
    v_cndmask_b32 v33, v33, v32, vcc
    v_cmp_lt_u32 vcc, 2048, v32
    v_mov_b32 v34, 700
    s_nop 0
    v_cndmask_b32 v33, v33, v34, vcc
    v_lshlrev_b32 v33, 2, v33
    v_add_u32 v33, s84, v33
    v_accvgpr_write_b32 a96, v33
    v_cmp_gt_u32 vcc, 256, v36
    s_nop 1
    v_cndmask_b32 v37, v37, v36, vcc
    v_cmp_lt_u32 vcc, 2048, v36
    v_mov_b32 v38, 700
    s_nop 0
    v_cndmask_b32 v37, v37, v38, vcc
    v_lshlrev_b32 v37, 2, v37
    v_add_u32 v37, s84, v37
    v_accvgpr_write_b32 a97, v37
    v_cmp_gt_u32 vcc, 256, v40
    s_nop 1
    v_cndmask_b32 v41, v41, v40, vcc
    v_cmp_lt_u32 vcc, 2048, v40
    v_mov_b32 v42, 700
    s_nop 0
    v_cndmask_b32 v41, v41, v42, vcc
    v_lshlrev_b32 v41, 2, v41
    v_add_u32 v41, s84, v41
    v_accvgpr_write_b32 a98, v41
    v_cmp_gt_u32 vcc, 256, v44
    s_nop 1
    v_cndmask_b32 v45, v45, v44, vcc
    v_cmp_lt_u32 vcc, 2048, v44
    v_mov_b32 v46, 700
    s_nop 0
    v_cndmask_b32 v45, v45, v46, vcc
    v_lshlrev_b32 v45, 2, v45
    v_add_u32 v45, s84, v45
    v_accvgpr_write_b32 a99, v45
    v_cmp_gt_u32 vcc, 256, v48
    s_nop 1
    v_cndmask_b32 v49, v49, v48, vcc
    v_cmp_lt_u32 vcc, 2048, v48
    v_mov_b32 v50, 700
    s_nop 0
    v_cndmask_b32 v49, v49, v50, vcc
    v_lshlrev_b32 v49, 2, v49
    v_add_u32 v49, s84, v49
    v_accvgpr_write_b32 a100, v49
    v_cmp_gt_u32 vcc, 256, v52
    s_nop 1
    v_cndmask_b32 v53, v53, v52, vcc
    v_cmp_lt_u32 vcc, 2048, v52
    v_mov_b32 v54, 700
    s_nop 0
    v_cndmask_b32 v53, v53, v54, vcc
    v_lshlrev_b32 v53, 2, v53
    v_add_u32 v53, s84, v53
    v_accvgpr_write_b32 a101, v53
    v_cmp_gt_u32 vcc, 256, v56
    s_nop 1
    v_cndmask_b32 v57, v57, v56, vcc
    v_cmp_lt_u32 vcc, 2048, v56
    v_mov_b32 v58, 700
    s_nop 0
    v_cndmask_b32 v57, v57, v58, vcc
    v_lshlrev_b32 v57, 2, v57
    v_add_u32 v57, s84, v57
    v_accvgpr_write_b32 a102, v57
    v_cmp_gt_u32 vcc, 256, v60
    s_nop 1
    v_cndmask_b32 v61, v61, v60, vcc
    v_cmp_lt_u32 vcc, 2048, v60
    v_mov_b32 v62, 700
    s_nop 0
    v_cndmask_b32 v61, v61, v62, vcc
    v_lshlrev_b32 v61, 2, v61
    v_add_u32 v61, s84, v61
    v_accvgpr_write_b32 a103, v61
    s_mul_i32 s91, s86, 1160
    v_add_u32 v2, s91, v1
    v_mov_b32 v6, 701
    v_sub_u32 v8, 2063, v2
    v_cvt_f32_i32 v9, v8
    v_cvt_pk_bf16_f32 v9, v9, v9
    v_and_b32 v9, 0xffff, v9
    v_subrev_u32 v9, 17024, v9
    v_cmp_gt_u32 vcc, 256, v8
    s_nop 1
    v_cndmask_b32 v9, v9, v8, vcc
    v_cmp_gt_u32 vcc, 2048, v8
    s_nop 1
    v_cndmask_b32 v9, v6, v9, vcc
    v_lshlrev_b32 v9, 2, v9
    v_add_u32 v9, s84, v9
    v_accvgpr_write_b32 a104, v9
    v_sub_u32 v12, 1999, v2
    v_cvt_f32_i32 v13, v12
    v_cvt_pk_bf16_f32 v13, v13, v13
    v_and_b32 v13, 0xffff, v13
    v_subrev_u32 v13, 17024, v13
    v_cmp_gt_u32 vcc, 256, v12
    s_nop 1
    v_cndmask_b32 v13, v13, v12, vcc
    v_cmp_gt_u32 vcc, 2048, v12
    s_nop 1
    v_cndmask_b32 v13, v6, v13, vcc
    v_lshlrev_b32 v13, 2, v13
    v_add_u32 v13, s84, v13
    v_accvgpr_write_b32 a105, v13
    v_sub_u32 v16, 1935, v2
    v_cvt_f32_i32 v17, v16
    v_cvt_pk_bf16_f32 v17, v17, v17
    v_and_b32 v17, 0xffff, v17
    v_subrev_u32 v17, 17024, v17
    v_cmp_gt_u32 vcc, 256, v16
    s_nop 1
    v_cndmask_b32 v17, v17, v16, vcc
    v_cmp_gt_u32 vcc, 2048, v16
    s_nop 1
    v_cndmask_b32 v17, v6, v17, vcc
    v_lshlrev_b32 v17, 2, v17
    v_add_u32 v17, s84, v17
    v_accvgpr_write_b32 a106, v17
    v_sub_u32 v20, 1871, v2
    v_cvt_f32_i32 v21, v20
    v_cvt_pk_bf16_f32 v21, v21, v21
    v_and_b32 v21, 0xffff, v21
    v_subrev_u32 v21, 17024, v21
    v_cmp_gt_u32 vcc, 256, v20
    s_nop 1
    v_cndmask_b32 v21, v21, v20, vcc
    v_cmp_gt_u32 vcc, 2048, v20
    s_nop 1
    v_cndmask_b32 v21, v6, v21, vcc
    v_lshlrev_b32 v21, 2, v21
    v_add_u32 v21, s84, v21
    v_accvgpr_write_b32 a107, v21
    v_sub_u32 v24, 1807, v2
    v_cvt_f32_i32 v25, v24
    v_cvt_pk_bf16_f32 v25, v25, v25
    v_and_b32 v25, 0xffff, v25
    v_subrev_u32 v25, 17024, v25
    v_cmp_gt_u32 vcc, 256, v24
    s_nop 1
    v_cndmask_b32 v25, v25, v24, vcc
    v_cmp_gt_u32 vcc, 2048, v24
    s_nop 1
    v_cndmask_b32 v25, v6, v25, vcc
    v_lshlrev_b32 v25, 2, v25
    v_add_u32 v25, s84, v25
    v_accvgpr_write_b32 a108, v25
    v_sub_u32 v28, 1743, v2
    v_cvt_f32_i32 v29, v28
    v_cvt_pk_bf16_f32 v29, v29, v29
    v_and_b32 v29, 0xffff, v29
    v_subrev_u32 v29, 17024, v29
    v_cmp_gt_u32 vcc, 256, v28
    s_nop 1
    v_cndmask_b32 v29, v29, v28, vcc
    v_cmp_gt_u32 vcc, 2048, v28
    s_nop 1
    v_cndmask_b32 v29, v6, v29, vcc
    v_lshlrev_b32 v29, 2, v29
    v_add_u32 v29, s84, v29
    v_accvgpr_write_b32 a109, v29
    v_sub_u32 v8, 1679, v2
    v_cvt_f32_i32 v9, v8
    v_cvt_pk_bf16_f32 v9, v9, v9
    v_and_b32 v9, 0xffff, v9
    v_subrev_u32 v9, 17024, v9
    v_cmp_gt_u32 vcc, 256, v8
    s_nop 1
    v_cndmask_b32 v9, v9, v8, vcc
    v_cmp_gt_u32 vcc, 2048, v8
    s_nop 1
    v_cndmask_b32 v9, v6, v9, vcc
    v_lshlrev_b32 v9, 2, v9
    v_add_u32 v9, s84, v9
    v_accvgpr_write_b32 a110, v9
    v_sub_u32 v12, 1615, v2
    v_cvt_f32_i32 v13, v12
    v_cvt_pk_bf16_f32 v13, v13, v13
    v_and_b32 v13, 0xffff, v13
    v_subrev_u32 v13, 17024, v13
    v_cmp_gt_u32 vcc, 256, v12
    s_nop 1
    v_cndmask_b32 v13, v13, v12, vcc
    v_cmp_gt_u32 vcc, 2048, v12
    s_nop 1
    v_cndmask_b32 v13, v6, v13, vcc
    v_lshlrev_b32 v13, 2, v13
    v_add_u32 v13, s84, v13
    v_accvgpr_write_b32 a111, v13
    v_sub_u32 v16, 1551, v2
    v_cvt_f32_i32 v17, v16
    v_cvt_pk_bf16_f32 v17, v17, v17
    v_and_b32 v17, 0xffff, v17
    v_subrev_u32 v17, 17024, v17
    v_cmp_gt_u32 vcc, 256, v16
    s_nop 1
    v_cndmask_b32 v17, v17, v16, vcc
    v_cmp_gt_u32 vcc, 2048, v16
    s_nop 1
    v_cndmask_b32 v17, v6, v17, vcc
    v_lshlrev_b32 v17, 2, v17
    v_add_u32 v17, s84, v17
    v_accvgpr_write_b32 a112, v17
    v_sub_u32 v20, 1487, v2
    v_cvt_f32_i32 v21, v20
    v_cvt_pk_bf16_f32 v21, v21, v21
    v_and_b32 v21, 0xffff, v21
    v_subrev_u32 v21, 17024, v21
    v_cmp_gt_u32 vcc, 256, v20
    s_nop 1
    v_cndmask_b32 v21, v21, v20, vcc
    v_cmp_gt_u32 vcc, 2048, v20
    s_nop 1
    v_cndmask_b32 v21, v6, v21, vcc
    v_lshlrev_b32 v21, 2, v21
    v_add_u32 v21, s84, v21
    v_accvgpr_write_b32 a113, v21
    v_sub_u32 v24, 1423, v2
    v_cvt_f32_i32 v25, v24
    v_cvt_pk_bf16_f32 v25, v25, v25
    v_and_b32 v25, 0xffff, v25
    v_subrev_u32 v25, 17024, v25
    v_cmp_gt_u32 vcc, 256, v24
    s_nop 1
    v_cndmask_b32 v25, v25, v24, vcc
    v_cmp_gt_u32 vcc, 2048, v24
    s_nop 1
    v_cndmask_b32 v25, v6, v25, vcc
    v_lshlrev_b32 v25, 2, v25
    v_add_u32 v25, s84, v25
    v_accvgpr_write_b32 a114, v25
    v_sub_u32 v28, 1359, v2
    v_cvt_f32_i32 v29, v28
    v_cvt_pk_bf16_f32 v29, v29, v29
    v_and_b32 v29, 0xffff, v29
    v_subrev_u32 v29, 17024, v29
    v_cmp_gt_u32 vcc, 256, v28
    s_nop 1
    v_cndmask_b32 v29, v29, v28, vcc
    v_cmp_gt_u32 vcc, 2048, v28
    s_nop 1
    v_cndmask_b32 v29, v6, v29, vcc
    v_lshlrev_b32 v29, 2, v29
    v_add_u32 v29, s84, v29
    v_accvgpr_write_b32 a115, v29
    v_sub_u32 v8, 1295, v2
    v_cvt_f32_i32 v9, v8
    v_cvt_pk_bf16_f32 v9, v9, v9
    v_and_b32 v9, 0xffff, v9
    v_subrev_u32 v9, 17024, v9
    v_cmp_gt_u32 vcc, 256, v8
    s_nop 1
    v_cndmask_b32 v9, v9, v8, vcc
    v_cmp_gt_u32 vcc, 2048, v8
    s_nop 1
    v_cndmask_b32 v9, v6, v9, vcc
    v_lshlrev_b32 v9, 2, v9
    v_add_u32 v9, s84, v9
    v_accvgpr_write_b32 a116, v9
    v_sub_u32 v12, 1231, v2
    v_cvt_f32_i32 v13, v12
    v_cvt_pk_bf16_f32 v13, v13, v13
    v_and_b32 v13, 0xffff, v13
    v_subrev_u32 v13, 17024, v13
    v_cmp_gt_u32 vcc, 256, v12
    s_nop 1
    v_cndmask_b32 v13, v13, v12, vcc
    v_cmp_gt_u32 vcc, 2048, v12
    s_nop 1
    v_cndmask_b32 v13, v6, v13, vcc
    v_lshlrev_b32 v13, 2, v13
    v_add_u32 v13, s84, v13
    v_accvgpr_write_b32 a117, v13
    v_sub_u32 v16, 1167, v2
    v_cvt_f32_i32 v17, v16
    v_cvt_pk_bf16_f32 v17, v17, v17
    v_and_b32 v17, 0xffff, v17
    v_subrev_u32 v17, 17024, v17
    v_cmp_gt_u32 vcc, 256, v16
    s_nop 1
    v_cndmask_b32 v17, v17, v16, vcc
    v_cmp_gt_u32 vcc, 2048, v16
    s_nop 1
    v_cndmask_b32 v17, v6, v17, vcc
    v_lshlrev_b32 v17, 2, v17
    v_add_u32 v17, s84, v17
    v_accvgpr_write_b32 a118, v17
    v_sub_u32 v20, 1103, v2
    v_cvt_f32_i32 v21, v20
    v_cvt_pk_bf16_f32 v21, v21, v21
    v_and_b32 v21, 0xffff, v21
    v_subrev_u32 v21, 17024, v21
    v_cmp_gt_u32 vcc, 256, v20
    s_nop 1
    v_cndmask_b32 v21, v21, v20, vcc
    v_cmp_gt_u32 vcc, 2048, v20
    s_nop 1
    v_cndmask_b32 v21, v6, v21, vcc
    v_lshlrev_b32 v21, 2, v21
    v_add_u32 v21, s84, v21
    v_accvgpr_write_b32 a119, v21
    v_sub_u32 v24, 1039, v2
    v_cvt_f32_i32 v25, v24
    v_cvt_pk_bf16_f32 v25, v25, v25
    v_and_b32 v25, 0xffff, v25
    v_subrev_u32 v25, 17024, v25
    v_cmp_gt_u32 vcc, 256, v24
    s_nop 1
    v_cndmask_b32 v25, v25, v24, vcc
    v_cmp_gt_u32 vcc, 2048, v24
    s_nop 1
    v_cndmask_b32 v25, v6, v25, vcc
    v_lshlrev_b32 v25, 2, v25
    v_add_u32 v25, s84, v25
    v_accvgpr_write_b32 a120, v25
    v_sub_u32 v28, 975, v2
    v_cvt_f32_i32 v29, v28
    v_cvt_pk_bf16_f32 v29, v29, v29
    v_and_b32 v29, 0xffff, v29
    v_subrev_u32 v29, 17024, v29
    v_cmp_gt_u32 vcc, 256, v28
    s_nop 1
    v_cndmask_b32 v29, v29, v28, vcc
    v_cmp_gt_u32 vcc, 2048, v28
    s_nop 1
    v_cndmask_b32 v29, v6, v29, vcc
    v_lshlrev_b32 v29, 2, v29
    v_add_u32 v29, s84, v29
    v_accvgpr_write_b32 a121, v29
    v_sub_u32 v8, 911, v2
    v_cvt_f32_i32 v9, v8
    v_cvt_pk_bf16_f32 v9, v9, v9
    v_and_b32 v9, 0xffff, v9
    v_subrev_u32 v9, 17024, v9
    v_cmp_gt_u32 vcc, 256, v8
    s_nop 1
    v_cndmask_b32 v9, v9, v8, vcc
    v_cmp_gt_u32 vcc, 2048, v8
    s_nop 1
    v_cndmask_b32 v9, v6, v9, vcc
    v_lshlrev_b32 v9, 2, v9
    v_add_u32 v9, s84, v9
    v_accvgpr_write_b32 a122, v9
    s_add_u32 s84, s84, 2804
    v_mov_b32 v6, s84
    v_mov_b32 v7, 0
    ds_write_b32 v6, v7
    s_mul_i32 s84, s87, 2560
    s_add_u32 s84, s84, 98304
    v_lshrrev_b32 v2, 4, v1
    v_mov_b32 v4, 0
    v_mov_b32 v5, 1.0
    v_mov_b32 v6, 2.0
    v_cmp_eq_u32 vcc, 1, v2
    v_mov_b32 v8, 1132462080
    s_nop 0
    v_cndmask_b32 v4, v4, v8, vcc
    v_mov_b32 v8, 1073741824
    v_cndmask_b32 v5, v5, v8, vcc
    v_mov_b32 v8, 1082130432
    v_cndmask_b32 v6, v6, v8, vcc
    v_cmp_eq_u32 vcc, 2, v2
    v_mov_b32 v8, 1140850688
    s_nop 0
    v_cndmask_b32 v4, v4, v8, vcc
    v_mov_b32 v8, 1082130432
    v_cndmask_b32 v5, v5, v8, vcc
    v_mov_b32 v8, 1132462080
    v_cndmask_b32 v6, v6, v8, vcc
    v_cmp_eq_u32 vcc, 3, v2
    v_mov_b32 v8, 1149239296
    s_nop 0
    v_cndmask_b32 v4, v4, v8, vcc
    v_mov_b32 v8, 1132462080
    v_cndmask_b32 v5, v5, v8, vcc
    v_mov_b32 v8, 1140850688
    v_cndmask_b32 v6, v6, v8, vcc
    v_lshlrev_b32 v7, 6, v2
    v_cvt_f32_u32 v7, v7
    v_and_b32 v3, 15, v1
    v_lshlrev_b32 v3, 2, v3
    s_mul_i32 s90, s87, 5120
    s_add_u32 s90, s90, 131584
    v_mul_u32_u24 v8, 80, v2
    v_add_u32 v8, v8, v3
    v_add_u32 v8, s90, v8
    v_add_u32 v3, s84, v3
    v_and_b32 v9, 7, v1
    v_lshlrev_b32 v9, 2, v9
    v_bfe_u32 v10, v1, 3, 2
    v_add_u32 v9, v9, v10
    v_mul_u32_u24 v9, 80, v9
    v_lshrrev_b32 v10, 5, v1
    v_lshl_add_u32 v9, v10, 4, v9
    v_add_u32 v9, s90, v9
    v_mov_b32 v10, 1090519040
    v_mov_b32 v11, 1098907648
    v_mov_b32 v99, v113
    v_mov_b32 v112, 0
    v_mov_b32 v113, 0
    v_mov_b32 v114, 0
    v_mov_b32 v115, 0
    v_mov_b32 v116, 0
    v_mov_b32 v117, 0
    v_mov_b32 v118, 0
    v_mov_b32 v119, 0
    v_mov_b32 v120, 0
    v_mov_b32 v121, 0
    v_mov_b32 v122, 0
    v_mov_b32 v123, 0
    v_mov_b32 v124, 0
    v_mov_b32 v125, 0
    v_mov_b32 v126, 0
    v_mov_b32 v127, 0
    v_mov_b32 v12, 152192
SW_5:
    ds_read_b32 v13, v12
    s_waitcnt lgkmcnt(0)
    v_readfirstlane_b32 s88, v13
    s_nop 0
    s_cmp_ge_u32 s88, 4
    s_cbranch_scc1 SW_5_ok
    s_sleep 2
    s_branch SW_5
SW_5_ok:
    v_accvgpr_write_b32 a0, 0
    v_accvgpr_write_b32 a1, 0
    v_accvgpr_write_b32 a2, 0
    v_accvgpr_write_b32 a3, 0
    v_accvgpr_write_b32 a4, 0
    v_accvgpr_write_b32 a5, 0
    v_accvgpr_write_b32 a6, 0
    v_accvgpr_write_b32 a7, 0
    v_accvgpr_write_b32 a8, 0
    v_accvgpr_write_b32 a9, 0
    v_accvgpr_write_b32 a10, 0
    v_accvgpr_write_b32 a11, 0
    v_accvgpr_write_b32 a12, 0
    v_accvgpr_write_b32 a13, 0
    v_accvgpr_write_b32 a14, 0
    v_accvgpr_write_b32 a15, 0
    s_waitcnt lgkmcnt(0)
    ds_read_b32 v12, v3
    ds_read_b32 v13, v3 offset:512
    ds_read_b32 v14, v3 offset:1024
    ds_read_b32 v16, v3 offset:1536
    ds_read_b32 v17, v3 offset:2048
    s_mov_b32 s88, 0
KG_6:
    s_waitcnt lgkmcnt(0)
    s_cmp_eq_u32 s88, 0
    s_cbranch_scc1 KGN_7
    ds_read_b128 a[0:3], v9 offset:0
    ds_read_b128 a[4:7], v9 offset:2560
    ds_read_b128 a[8:11], v9 offset:32
    ds_read_b128 a[12:15], v9 offset:2592
KGN_7:
    v_mul_f32 v64, v13, v4
    v_mul_f32 v66, v13, v5
    v_mul_f32 v68, v13, v6
    v_mul_f32 v70, v13, v7
    v_mul_f32 v72, v13, v10
    v_mul_f32 v74, v13, v11
    v_mul_f32 v20, v12, v4
    v_mul_f32 v22, v12, v5
    v_mul_f32 v24, v12, v6
    v_mul_f32 v26, v12, v7
    v_mul_f32 v28, v12, v10
    v_mul_f32 v30, v12, v11
    v_fract_f32 v64, v64
    v_fract_f32 v66, v66
    v_fract_f32 v68, v68
    v_fract_f32 v70, v70
    v_fract_f32 v72, v72
    v_fract_f32 v74, v74
    v_exp_f32 v20, v20
    v_exp_f32 v22, v22
    v_exp_f32 v24, v24
    v_exp_f32 v26, v26
    v_exp_f32 v28, v28
    v_exp_f32 v30, v30
    v_fma_f32 v64, v14, v4, v64
    v_fma_f32 v66, v14, v5, v66
    v_fma_f32 v68, v14, v6, v68
    v_fma_f32 v70, v14, v7, v70
    v_fma_f32 v72, v14, v10, v72
    v_fma_f32 v74, v14, v11, v74
    v_sin_f32 v65, v64
    v_sin_f32 v67, v66
    v_sin_f32 v69, v68
    v_sin_f32 v71, v70
    v_sin_f32 v73, v72
    v_sin_f32 v75, v74
    v_cos_f32 v64, v64
    v_cos_f32 v66, v66
    v_cos_f32 v68, v68
    v_cos_f32 v70, v70
    v_cos_f32 v72, v72
    v_cos_f32 v74, v74
    v_mul_f32 v21, -v20, v65
    v_mul_f32 v23, -v22, v67
    v_mul_f32 v25, -v24, v69
    v_mul_f32 v27, v26, v71
    v_mul_f32 v29, v28, v73
    v_mul_f32 v31, v30, v75
    v_mul_f32 v20, v20, v64
    v_mul_f32 v22, v22, v66
    v_mul_f32 v24, v24, v68
    v_mul_f32 v26, v26, v70
    v_mul_f32 v28, v28, v72
    v_mul_f32 v30, v30, v74
    v_xor_b32 v17, 0x80000000, v17
    s_waitcnt lgkmcnt(0)
    v_mfma_f32_32x32x16_bf16 v[112:127], a[0:3], a[4:7], v[112:127]
    v_mul_f32 v64, v16, v20
    v_mov_b32 v48, v26
    v_mul_f32 v65, v16, v21
    v_mov_b32 v49, v27
    v_fma_f32 v32, -v17, v21, v64
    v_mul_f32 v68, v48, v30
    v_mul_f32 v70, v48, v28
    v_fma_f32 v33, v17, v20, v65
    v_mul_f32 v69, v48, v31
    v_mul_f32 v71, v48, v29
    v_mul_f32 v64, v32, v24
    v_mul_f32 v66, v32, v22
    v_fma_f32 v52, -v49, v31, v68
    v_fma_f32 v50, -v49, v29, v70
    v_mul_f32 v65, v32, v25
    v_mul_f32 v67, v32, v23
    v_fma_f32 v53, v49, v30, v69
    v_fma_f32 v51, v49, v28, v71
    v_fma_f32 v36, -v33, v25, v64
    v_fma_f32 v34, -v33, v23, v66
    v_mul_f32 v68, v52, v30
    v_mul_f32 v70, v50, v30
    v_fma_f32 v37, v33, v24, v65
    v_fma_f32 v35, v33, v22, v67
    v_mul_f32 v69, v52, v31
    v_mul_f32 v71, v50, v31
    v_mul_f32 v64, v36, v24
    v_mul_f32 v66, v34, v24
    v_fma_f32 v56, -v53, v31, v68
    v_fma_f32 v54, -v51, v31, v70
    v_mul_f32 v65, v36, v25
    v_mfma_f32_32x32x16_bf16 v[112:127], a[8:11], a[12:15], v[112:127]
    v_mul_f32 v67, v34, v25
    v_fma_f32 v57, v53, v30, v69
    v_fma_f32 v55, v51, v30, v71
    v_fma_f32 v40, -v37, v25, v64
    v_fma_f32 v38, -v35, v25, v66
    v_mul_f32 v68, v56, v30
    v_mul_f32 v70, v54, v30
    v_fma_f32 v41, v37, v24, v65
    v_fma_f32 v39, v35, v24, v67
    v_mul_f32 v69, v56, v31
    v_mul_f32 v71, v54, v31
    v_mul_f32 v64, v40, v24
    v_mul_f32 v66, v38, v24
    v_fma_f32 v60, -v57, v31, v68
    v_fma_f32 v58, -v55, v31, v70
    v_mul_f32 v65, v40, v25
    v_mul_f32 v67, v38, v25
    v_fma_f32 v61, v57, v30, v69
    v_fma_f32 v59, v55, v30, v71
    v_fma_f32 v44, -v41, v25, v64
    v_fma_f32 v42, -v39, v25, v66
    v_mul_f32 v70, v58, v30
    v_fma_f32 v45, v41, v24, v65
    v_fma_f32 v43, v39, v24, v67
    v_mul_f32 v71, v58, v31
    v_mul_f32 v66, v42, v24
    v_fma_f32 v62, -v59, v31, v70
    v_mul_f32 v67, v42, v25
    v_fma_f32 v63, v59, v30, v71
    v_fma_f32 v46, -v43, v25, v66
    v_fma_f32 v47, v43, v24, v67
    v_add_u32 v3, 64, v3
    ds_read_b32 v12, v3
    ds_read_b32 v13, v3 offset:512
    ds_read_b32 v14, v3 offset:1024
    ds_read_b32 v16, v3 offset:1536
    ds_read_b32 v17, v3 offset:2048
    v_cvt_pk_bf16_f32 v64, v32, v33
    v_cvt_pk_bf16_f32 v72, v48, v49
    v_cvt_pk_bf16_f32 v65, v34, v35
    v_cvt_pk_bf16_f32 v73, v50, v51
    v_cvt_pk_bf16_f32 v66, v36, v37
    v_cvt_pk_bf16_f32 v74, v52, v53
    v_cvt_pk_bf16_f32 v67, v38, v39
    v_cvt_pk_bf16_f32 v75, v54, v55
    v_cvt_pk_bf16_f32 v68, v40, v41
    v_cvt_pk_bf16_f32 v76, v56, v57
    v_cvt_pk_bf16_f32 v69, v42, v43
    v_cvt_pk_bf16_f32 v77, v58, v59
    v_cvt_pk_bf16_f32 v70, v44, v45
    v_cvt_pk_bf16_f32 v78, v60, v61
    v_cvt_pk_bf16_f32 v71, v46, v47
    v_cvt_pk_bf16_f32 v79, v62, v63
    ds_write_b32 v8, v64 offset:0
    ds_write_b32 v8, v72 offset:2560
    ds_write_b32 v8, v65 offset:320
    ds_write_b32 v8, v73 offset:2880
    ds_write_b32 v8, v66 offset:640
    ds_write_b32 v8, v74 offset:3200
    ds_write_b32 v8, v67 offset:960
    ds_write_b32 v8, v75 offset:3520
    ds_write_b32 v8, v68 offset:1280
    ds_write_b32 v8, v76 offset:3840
    ds_write_b32 v8, v69 offset:1600
    ds_write_b32 v8, v77 offset:4160
    ds_write_b32 v8, v70 offset:1920
    ds_write_b32 v8, v78 offset:4480
    ds_write_b32 v8, v71 offset:2240
    ds_write_b32 v8, v79 offset:4800
    s_add_u32 s88, s88, 1
    s_cmp_lt_u32 s88, 8
    s_cbranch_scc1 KG_6
    s_waitcnt lgkmcnt(0)
    ds_read_b128 a[0:3], v9 offset:0
    ds_read_b128 a[4:7], v9 offset:2560
    ds_read_b128 a[8:11], v9 offset:32
    ds_read_b128 a[12:15], v9 offset:2592
    s_waitcnt lgkmcnt(0)
    v_mfma_f32_32x32x16_bf16 v[112:127], a[0:3], a[4:7], v[112:127]
    v_mfma_f32_32x32x16_bf16 v[112:127], a[8:11], a[12:15], v[112:127]
    s_and_b32 s92, s2, 7
    s_lshr_b32 s93, s2, 3
    s_mul_i32 s94, s93, 37
    s_lshr_b32 s94, s94, 8
    s_mul_i32 s95, s94, 7
    s_sub_u32 s95, s93, s95
    s_and_b32 s96, s92, 1
    s_mul_i32 s96, s96, 7
    s_add_u32 s96, s96, s95
    s_mul_i32 s97, s94, 448
    s_mul_i32 s98, s87, 112
    s_add_u32 s97, s97, s98
    v_min_u32 v6, 55, v1
    v_add_u32 v6, s97, v6
    v_mul_u32_u24 v6, 896, v6
    s_lshl_b32 s97, s95, 7
    v_add_u32 v6, s97, v6
    global_load_dword v98, v6, s[40:41]
    v_add_u32 v6, 50176, v6
    global_load_dword v100, v6, s[40:41]
    s_lshl_b32 s84, s87, 12
    s_add_u32 s84, s84, 108544
    v_lshrrev_b32 v3, 5, v1
    v_lshlrev_b32 v3, 9, v3
    v_and_b32 v6, 31, v1
    v_lshl_add_u32 v3, v6, 2, v3
    v_add_u32 v6, s84, v3
    ds_write_b32 v6, v112 offset:0
    ds_write_b32 v6, v113 offset:128
    ds_write_b32 v6, v114 offset:256
    ds_write_b32 v6, v115 offset:384
    ds_write_b32 v6, v116 offset:1024
    ds_write_b32 v6, v117 offset:1152
    ds_write_b32 v6, v118 offset:1280
    ds_write_b32 v6, v119 offset:1408
    ds_write_b32 v6, v120 offset:2048
    ds_write_b32 v6, v121 offset:2176
    ds_write_b32 v6, v122 offset:2304
    ds_write_b32 v6, v123 offset:2432
    ds_write_b32 v6, v124 offset:3072
    ds_write_b32 v6, v125 offset:3200
    ds_write_b32 v6, v126 offset:3328
    ds_write_b32 v6, v127 offset:3456
    s_lshr_b32 s89, s87, 1
    s_lshl_b32 s89, s89, 2
    s_add_u32 s89, s89, 152200
    s_waitcnt lgkmcnt(0)
    v_mov_b32 v7, 152284
    v_mov_b32 v8, 1
    s_mov_b64 exec, 1
    ds_add_u32 v7, v8
    s_mov_b64 exec, -1
SYNC_8:
    ds_read_b32 v8, v7
    s_waitcnt lgkmcnt(0)
    v_readfirstlane_b32 s84, v8
    s_nop 0
    s_cmp_ge_u32 s84, 4
    s_cbranch_scc0 SYNC_8
    s_xor_b32 s84, s87, 1
    s_lshl_b32 s84, s84, 12
    s_add_u32 s84, s84, 108544
    s_lshl_b32 s90, s86, 11
    s_add_u32 s84, s84, s90
    v_add_u32 v6, s84, v3
    s_lshr_b32 s84, s87, 1
    s_lshl_b32 s84, s84, 12
    s_add_u32 s84, s84, 124928
    ds_read_b32 v8, v6 offset:0
    ds_read_b32 v9, v6 offset:128
    ds_read_b32 v10, v6 offset:256
    ds_read_b32 v11, v6 offset:384
    ds_read_b32 v12, v6 offset:1024
    ds_read_b32 v13, v6 offset:1152
    ds_read_b32 v14, v6 offset:1280
    ds_read_b32 v15, v6 offset:1408
    s_cmp_eq_u32 s86, 0
    s_cselect_b64 vcc, -1, 0
    v_cndmask_b32 v16, v120, v112, vcc
    v_cndmask_b32 v17, v121, v113, vcc
    v_cndmask_b32 v18, v122, v114, vcc
    v_cndmask_b32 v19, v123, v115, vcc
    v_cndmask_b32 v20, v124, v116, vcc
    v_cndmask_b32 v21, v125, v117, vcc
    v_cndmask_b32 v22, v126, v118, vcc
    v_cndmask_b32 v23, v127, v119, vcc
    v_accvgpr_read_b32 v33, a96
    v_accvgpr_read_b32 v37, a97
    v_accvgpr_read_b32 v41, a98
    v_accvgpr_read_b32 v45, a99
    v_accvgpr_read_b32 v49, a100
    v_accvgpr_read_b32 v53, a101
    v_accvgpr_read_b32 v57, a102
    v_accvgpr_read_b32 v61, a103
    s_waitcnt lgkmcnt(0)
    v_add_f32 v8, v8, v16
    v_cvt_pk_bf16_f32 v8, v8, v8
    ds_write_b32 v33, v8
    v_add_f32 v9, v9, v17
    v_cvt_pk_bf16_f32 v9, v9, v9
    ds_write_b32 v37, v9
    v_add_f32 v10, v10, v18
    v_cvt_pk_bf16_f32 v10, v10, v10
    ds_write_b32 v41, v10
    v_add_f32 v11, v11, v19
    v_cvt_pk_bf16_f32 v11, v11, v11
    ds_write_b32 v45, v11
    v_add_f32 v12, v12, v20
    v_cvt_pk_bf16_f32 v12, v12, v12
    ds_write_b32 v49, v12
    v_add_f32 v13, v13, v21
    v_cvt_pk_bf16_f32 v13, v13, v13
    ds_write_b32 v53, v13
    v_add_f32 v14, v14, v22
    v_cvt_pk_bf16_f32 v14, v14, v14
    ds_write_b32 v57, v14
    v_add_f32 v15, v15, v23
    v_cvt_pk_bf16_f32 v15, v15, v15
    ds_write_b32 v61, v15
    s_waitcnt lgkmcnt(0)
    v_mov_b32 v7, s89
    v_mov_b32 v8, 1
    s_mov_b64 exec, 1
    ds_add_u32 v7, v8
    s_mov_b64 exec, -1
SYNC_9:
    ds_read_b32 v8, v7
    s_waitcnt lgkmcnt(0)
    v_readfirstlane_b32 s84, v8
    s_nop 0
    s_cmp_ge_u32 s84, 2
    s_cbranch_scc0 SYNC_9
    s_lshr_b32 s84, s87, 1
    s_mul_i32 s90, s84, 9280
    s_add_u32 s90, s90, 133632
    s_mul_i32 s91, s86, 1160
    v_add_u32 v2, s91, v1
    v_lshlrev_b32 v3, 1, v2
    v_add_u32 v3, s90, v3
    v_accvgpr_read_b32 v8, a104
    v_accvgpr_read_b32 v9, a105
    v_accvgpr_read_b32 v10, a106
    v_accvgpr_read_b32 v11, a107
    v_accvgpr_read_b32 v12, a108
    v_accvgpr_read_b32 v13, a109
    v_accvgpr_read_b32 v14, a110
    v_accvgpr_read_b32 v15, a111
    v_accvgpr_read_b32 v16, a112
    v_accvgpr_read_b32 v17, a113
    v_accvgpr_read_b32 v18, a114
    v_accvgpr_read_b32 v19, a115
    v_accvgpr_read_b32 v20, a116
    v_accvgpr_read_b32 v21, a117
    v_accvgpr_read_b32 v22, a118
    v_accvgpr_read_b32 v23, a119
    v_accvgpr_read_b32 v24, a120
    v_accvgpr_read_b32 v25, a121
    v_accvgpr_read_b32 v26, a122
    ds_read_b32 v32, v8
    ds_read_b32 v33, v9
    ds_read_b32 v34, v10
    ds_read_b32 v35, v11
    ds_read_b32 v36, v12
    ds_read_b32 v37, v13
    ds_read_b32 v38, v14
    ds_read_b32 v39, v15
    ds_read_b32 v40, v16
    ds_read_b32 v41, v17
    ds_read_b32 v42, v18
    ds_read_b32 v43, v19
    ds_read_b32 v44, v20
    ds_read_b32 v45, v21
    ds_read_b32 v46, v22
    ds_read_b32 v47, v23
    ds_read_b32 v48, v24
    ds_read_b32 v49, v25
    ds_read_b32 v50, v26
    s_waitcnt lgkmcnt(0)
    ds_write_b16 v3, v32 offset:0
    ds_write_b16 v3, v33 offset:128
    ds_write_b16 v3, v34 offset:256
    ds_write_b16 v3, v35 offset:384
    ds_write_b16 v3, v36 offset:512
    ds_write_b16 v3, v37 offset:640
    ds_write_b16 v3, v38 offset:768
    ds_write_b16 v3, v39 offset:896
    ds_write_b16 v3, v40 offset:1024
    ds_write_b16 v3, v41 offset:1152
    ds_write_b16 v3, v42 offset:1280
    ds_write_b16 v3, v43 offset:1408
    ds_write_b16 v3, v44 offset:1536
    ds_write_b16 v3, v45 offset:1664
    ds_write_b16 v3, v46 offset:1792
    ds_write_b16 v3, v47 offset:1920
    ds_write_b16 v3, v48 offset:2048
    ds_write_b16 v3, v49 offset:2176
    v_cmp_gt_u32 vcc, 1168, v2
    s_nop 0
    s_and_saveexec_b64 s[92:93], vcc
    ds_write_b16 v3, v50 offset:2304
    s_mov_b64 exec, s[92:93]
    s_waitcnt lgkmcnt(0)
    v_mov_b32 v7, 152196
    v_mov_b32 v8, 1
    s_mov_b64 exec, 1
    ds_add_u32 v7, v8
    s_mov_b64 exec, -1
SYNC_10:
    ds_read_b32 v8, v7
    s_waitcnt lgkmcnt(0)
    v_readfirstlane_b32 s84, v8
    s_nop 0
    s_cmp_ge_u32 s84, 4
    s_cbranch_scc0 SYNC_10
    s_cmp_lg_u32 s3, 4
    s_cbranch_scc1 SN_11
    v_mov_b32 v2, 152264
LNON_12:
    ds_read_b64 v[6:7], v2
    s_waitcnt lgkmcnt(0)
    v_readfirstlane_b32 s12, v6
    v_readfirstlane_b32 s13, v7
    s_cmp_lg_u32 s12, 0
    s_cbranch_scc0 LNON_12
SN_11:
    v_mov_b32 v2, 152208
    s_cmp_lg_u32 s3, 4
    s_cbranch_scc1 LNA_13_w
    v_lshlrev_b32 v3, 7, v1
LNA_13:
    s_mov_b32 s84, 131072
    buffer_load_dwordx2 v[8:9], v3, s[8:11], s84 offen sc0 sc1
    s_mov_b32 s84, 139264
    buffer_load_dwordx2 v[10:11], v3, s[8:11], s84 offen sc0 sc1
    s_mov_b32 s84, 147456
    buffer_load_dwordx2 v[12:13], v3, s[8:11], s84 offen sc0 sc1
    s_mov_b32 s84, 155648
    buffer_load_dwordx2 v[14:15], v3, s[8:11], s84 offen sc0 sc1
    s_waitcnt vmcnt(0)
    s_mov_b64 s[14:15], -1
    v_cmp_eq_u32 vcc, s12, v8
    s_nop 0
    s_and_b64 s[14:15], s[14:15], vcc
    v_cmp_eq_u32 vcc, s13, v9
    s_nop 0
    s_and_b64 s[14:15], s[14:15], vcc
    v_cmp_eq_u32 vcc, s12, v10
    s_nop 0
    s_and_b64 s[14:15], s[14:15], vcc
    v_cmp_eq_u32 vcc, s13, v11
    s_nop 0
    s_and_b64 s[14:15], s[14:15], vcc
    v_cmp_eq_u32 vcc, s12, v12
    s_nop 0
    s_and_b64 s[14:15], s[14:15], vcc
    v_cmp_eq_u32 vcc, s13, v13
    s_nop 0
    s_and_b64 s[14:15], s[14:15], vcc
    v_cmp_eq_u32 vcc, s12, v14
    s_nop 0
    s_and_b64 s[14:15], s[14:15], vcc
    v_cmp_eq_u32 vcc, s13, v15
    s_nop 0
    s_and_b64 s[14:15], s[14:15], vcc
    s_cmp_eq_u64 s[14:15], -1
    s_cbranch_scc1 LNA_13_ok
    s_sleep 2
    s_branch LNA_13
LNA_13_ok:
    v_mov_b32 v6, 1
    ds_write_b32 v2, v6
    s_branch LNA_13_done
LNA_13_w:
    ds_read_b32 v6, v2
    s_waitcnt lgkmcnt(0)
    v_readfirstlane_b32 s84, v6
    s_nop 0
    s_cmp_eq_u32 s84, 1
    s_cbranch_scc1 LNA_13_done
    s_sleep 1
    s_branch LNA_13_w
LNA_13_done:
    s_lshl_b32 s84, s85, 12
    s_add_u32 s84, s84, 12582912
    s_add_u32 s68, s46, s84
    s_addc_u32 s69, s47, 0
    s_mov_b32 s70, 4096
    s_mov_b32 s71, 0x00020000
    s_lshr_b32 s84, s87, 1
    s_mul_i32 s91, s84, 8448
    s_add_u32 s91, s91, 114688
    s_lshl_b32 s90, s86, 11
    s_add_u32 s90, s90, s91
    s_lshl_b32 s84, s86, 7
    v_add_u32 v8, s84, v1
    v_mul_u32_u24 v8, 7168, v8
    s_lshl_b32 s84, s85, 4
    v_add_u32 v8, s84, v8
    v_mov_b32 v9, 0
    s_add_u32 m0, s90, 64
    s_mov_b32 s84, 0
    buffer_load_dwordx4 v8, s[56:59], s84 offen sc1 lds
    s_add_u32 m0, s90, 1088
    s_mov_b32 s84, 458752
    buffer_load_dwordx4 v8, s[56:59], s84 offen sc1 lds
    v_and_b32 v10, 15, v1
    v_lshlrev_b32 v10, 2, v10
    s_mul_i32 s84, s86, 4160
    s_add_u32 s84, s84, s91
    v_add_u32 v10, s84, v10
    ds_write_b32 v10, v9
    ds_write_b32 v10, v9 offset:4224
    s_waitcnt vmcnt(0)
    s_waitcnt lgkmcnt(0)
    v_mov_b32 v12, s89
    v_mov_b32 v13, 1
    s_mov_b64 exec, 1
    ds_add_u32 v12, v13
    s_mov_b64 exec, -1
SYNC_14:
    ds_read_b32 v13, v12
    s_waitcnt lgkmcnt(0)
    v_readfirstlane_b32 s84, v13
    s_nop 0
    s_cmp_ge_u32 s84, 4
    s_cbranch_scc0 SYNC_14
    s_lshl_b32 s84, s86, 11
    s_add_u32 s84, s84, s91
    s_add_u32 s84, s84, 48
    v_lshlrev_b32 v10, 4, v1
    v_add_u32 v10, s84, v10
    ds_read_b128 v[16:19], v10 offset:0
    ds_read_b32 v20, v10 offset:16
    ds_read_b128 v[24:27], v10 offset:1024
    ds_read_b32 v28, v10 offset:1040
    ds_read_b128 v[32:35], v10 offset:2048
    ds_read_b32 v36, v10 offset:2064
    s_waitcnt lgkmcnt(0)
    v_alignbit_b32 v16, v17, v16, 16
    v_alignbit_b32 v17, v18, v17, 16
    v_alignbit_b32 v18, v19, v18, 16
    v_alignbit_b32 v19, v20, v19, 16
    ds_write_b128 v10, v[16:19] offset:4224
    v_alignbit_b32 v24, v25, v24, 16
    v_alignbit_b32 v25, v26, v25, 16
    v_alignbit_b32 v26, v27, v26, 16
    v_alignbit_b32 v27, v28, v27, 16
    ds_write_b128 v10, v[24:27] offset:5248
    v_alignbit_b32 v32, v33, v32, 16
    v_alignbit_b32 v33, v34, v33, 16
    v_alignbit_b32 v34, v35, v34, 16
    v_alignbit_b32 v35, v36, v35, 16
    v_cmp_gt_u32 vcc, 2, v1
    s_nop 0
    s_and_saveexec_b64 s[92:93], vcc
    ds_write_b128 v10, v[32:35] offset:6272
    s_mov_b64 exec, s[92:93]
    s_waitcnt lgkmcnt(0)
    v_mov_b32 v12, s89
    v_mov_b32 v13, 1
    s_mov_b64 exec, 1
    ds_add_u32 v12, v13
    s_mov_b64 exec, -1
SYNC_15:
    ds_read_b32 v13, v12
    s_waitcnt lgkmcnt(0)
    v_readfirstlane_b32 s84, v13
    s_nop 0
    s_cmp_ge_u32 s84, 6
    s_cbranch_scc0 SYNC_15
    s_lshr_b32 s84, s87, 1
    s_mul_i32 s84, s84, 9280
    s_lshl_b32 s90, s86, 6
    s_add_u32 s84, s84, s90
    s_add_u32 s84, s84, 134112
    v_and_b32 v4, 15, v1
    v_lshrrev_b32 v5, 4, v1
    v_lshlrev_b32 v6, 5, v4
    v_lshlrev_b32 v7, 4, v5
    v_sub_u32 v3, v7, v6
    v_add_u32 v3, s84, v3
    v_lshl_add_u32 v2, v4, 1, v7
    v_and_b32 v6, 1, v4
    v_xor_b32 v6, 1, v6
    v_mul_u32_u24 v6, 4222, v6
    v_add_u32 v2, v2, v6
    s_add_u32 s84, s91, 2
    s_add_u32 s84, s84, s90
    v_add_u32 v2, s84, v2
    v_accvgpr_write_b32 a0, 0
    v_accvgpr_write_b32 a1, 0
    v_accvgpr_write_b32 a2, 0
    v_accvgpr_write_b32 a3, 0
    v_accvgpr_write_b32 a4, 0
    v_accvgpr_write_b32 a5, 0
    v_accvgpr_write_b32 a6, 0
    v_accvgpr_write_b32 a7, 0
    v_accvgpr_write_b32 a8, 0
    v_accvgpr_write_b32 a9, 0
    v_accvgpr_write_b32 a10, 0
    v_accvgpr_write_b32 a11, 0
    v_accvgpr_write_b32 a12, 0
    v_accvgpr_write_b32 a13, 0
    v_accvgpr_write_b32 a14, 0
    v_accvgpr_write_b32 a15, 0
    v_accvgpr_write_b32 a16, 0
    v_accvgpr_write_b32 a17, 0
    v_accvgpr_write_b32 a18, 0
    v_accvgpr_write_b32 a19, 0
    v_accvgpr_write_b32 a20, 0
    v_accvgpr_write_b32 a21, 0
    v_accvgpr_write_b32 a22, 0
    v_accvgpr_write_b32 a23, 0
    v_accvgpr_write_b32 a24, 0
    v_accvgpr_write_b32 a25, 0
    v_accvgpr_write_b32 a26, 0
    v_accvgpr_write_b32 a27, 0
    v_accvgpr_write_b32 a28, 0
    v_accvgpr_write_b32 a29, 0
    v_accvgpr_write_b32 a30, 0
    v_accvgpr_write_b32 a31, 0
    v_add_u32 v8, 4096, v2
    v_subrev_u32 v8, s90, v8
    v_subrev_u32 v9, s90, v3
    ds_read2_b32 v[12:13], v8 offset0:0 offset1:1
    ds_read2_b32 v[14:15], v8 offset0:2 offset1:3
    ds_read_b128 v[16:19], v9 offset:4096
    v_add_u32 v8, 0, v2
    v_add_u32 v9, 1024, v2
    v_add_u32 v10, 2048, v2
    v_add_u32 v11, 3072, v2
    ds_read2_b32 v[32:33], v8 offset0:0 offset1:1
    ds_read2_b32 v[34:35], v8 offset0:2 offset1:3
    ds_read_b128 v[64:67], v3 offset:3584
    ds_read2_b32 v[36:37], v8 offset0:128 offset1:129
    ds_read2_b32 v[38:39], v8 offset0:130 offset1:131
    ds_read_b128 v[68:71], v3 offset:3072
    ds_read2_b32 v[40:41], v9 offset0:0 offset1:1
    ds_read2_b32 v[42:43], v9 offset0:2 offset1:3
    ds_read_b128 v[72:75], v3 offset:2560
    ds_read2_b32 v[44:45], v9 offset0:128 offset1:129
    ds_read2_b32 v[46:47], v9 offset0:130 offset1:131
    ds_read_b128 v[76:79], v3 offset:2048
    ds_read2_b32 v[48:49], v10 offset0:0 offset1:1
    ds_read2_b32 v[50:51], v10 offset0:2 offset1:3
    ds_read_b128 v[80:83], v3 offset:1536
    ds_read2_b32 v[52:53], v10 offset0:128 offset1:129
    ds_read2_b32 v[54:55], v10 offset0:130 offset1:131
    ds_read_b128 v[84:87], v3 offset:1024
    ds_read2_b32 v[56:57], v11 offset0:0 offset1:1
    ds_read2_b32 v[58:59], v11 offset0:2 offset1:3
    ds_read_b128 v[88:91], v3 offset:512
    ds_read2_b32 v[60:61], v11 offset0:128 offset1:129
    ds_read2_b32 v[62:63], v11 offset0:130 offset1:131
    ds_read_b128 v[92:95], v3 offset:0
    s_waitcnt lgkmcnt(0)
    v_mfma_f32_16x16x32_bf16 a[0:3], v[32:35], v[64:67], a[0:3]
    v_add_u32 v8, 128, v2
    v_mfma_f32_16x16x32_bf16 a[4:7], v[32:35], v[68:71], a[4:7]
    v_add_u32 v9, 1152, v2
    v_mfma_f32_16x16x32_bf16 a[8:11], v[32:35], v[72:75], a[8:11]
    v_add_u32 v10, 2176, v2
    v_mfma_f32_16x16x32_bf16 a[12:15], v[32:35], v[76:79], a[12:15]
    v_add_u32 v11, 3200, v2
    v_mfma_f32_16x16x32_bf16 a[16:19], v[32:35], v[80:83], a[16:19]
    ds_read2_b32 a[32:33], v8 offset0:0 offset1:1
    v_mfma_f32_16x16x32_bf16 a[20:23], v[32:35], v[84:87], a[20:23]
    ds_read2_b32 a[34:35], v8 offset0:2 offset1:3
    v_mfma_f32_16x16x32_bf16 a[24:27], v[32:35], v[88:91], a[24:27]
    ds_read_b128 a[64:67], v3 offset:3712
    v_mfma_f32_16x16x32_bf16 a[28:31], v[32:35], v[92:95], a[28:31]
    ds_read2_b32 a[36:37], v8 offset0:128 offset1:129
    v_mfma_f32_16x16x32_bf16 a[4:7], v[36:39], v[64:67], a[4:7]
    ds_read2_b32 a[38:39], v8 offset0:130 offset1:131
    v_mfma_f32_16x16x32_bf16 a[8:11], v[36:39], v[68:71], a[8:11]
    ds_read_b128 a[68:71], v3 offset:3200
    v_mfma_f32_16x16x32_bf16 a[12:15], v[36:39], v[72:75], a[12:15]
    ds_read2_b32 a[40:41], v9 offset0:0 offset1:1
    v_mfma_f32_16x16x32_bf16 a[16:19], v[36:39], v[76:79], a[16:19]
    ds_read2_b32 a[42:43], v9 offset0:2 offset1:3
    v_mfma_f32_16x16x32_bf16 a[20:23], v[36:39], v[80:83], a[20:23]
    ds_read_b128 a[72:75], v3 offset:2688
    v_mfma_f32_16x16x32_bf16 a[24:27], v[36:39], v[84:87], a[24:27]
    ds_read2_b32 a[44:45], v9 offset0:128 offset1:129
    v_mfma_f32_16x16x32_bf16 a[28:31], v[36:39], v[88:91], a[28:31]
    ds_read2_b32 a[46:47], v9 offset0:130 offset1:131
    v_mfma_f32_16x16x32_bf16 a[8:11], v[40:43], v[64:67], a[8:11]
    ds_read_b128 a[76:79], v3 offset:2176
    v_mfma_f32_16x16x32_bf16 a[12:15], v[40:43], v[68:71], a[12:15]
    ds_read2_b32 a[48:49], v10 offset0:0 offset1:1
    v_mfma_f32_16x16x32_bf16 a[16:19], v[40:43], v[72:75], a[16:19]
    ds_read2_b32 a[50:51], v10 offset0:2 offset1:3
    v_mfma_f32_16x16x32_bf16 a[20:23], v[40:43], v[76:79], a[20:23]
    ds_read_b128 a[80:83], v3 offset:1664
    v_mfma_f32_16x16x32_bf16 a[24:27], v[40:43], v[80:83], a[24:27]
    ds_read2_b32 a[52:53], v10 offset0:128 offset1:129
    v_mfma_f32_16x16x32_bf16 a[28:31], v[40:43], v[84:87], a[28:31]
    ds_read2_b32 a[54:55], v10 offset0:130 offset1:131
    v_mfma_f32_16x16x32_bf16 a[12:15], v[44:47], v[64:67], a[12:15]
    ds_read_b128 a[84:87], v3 offset:1152
    v_mfma_f32_16x16x32_bf16 a[16:19], v[44:47], v[68:71], a[16:19]
    ds_read2_b32 a[56:57], v11 offset0:0 offset1:1
    v_mfma_f32_16x16x32_bf16 a[20:23], v[44:47], v[72:75], a[20:23]
    ds_read2_b32 a[58:59], v11 offset0:2 offset1:3
    v_mfma_f32_16x16x32_bf16 a[24:27], v[44:47], v[76:79], a[24:27]
    ds_read_b128 a[88:91], v3 offset:640
    v_mfma_f32_16x16x32_bf16 a[28:31], v[44:47], v[80:83], a[28:31]
    ds_read2_b32 a[60:61], v11 offset0:128 offset1:129
    v_mfma_f32_16x16x32_bf16 a[16:19], v[48:51], v[64:67], a[16:19]
    ds_read2_b32 a[62:63], v11 offset0:130 offset1:131
    v_mfma_f32_16x16x32_bf16 a[20:23], v[48:51], v[68:71], a[20:23]
    ds_read_b128 a[92:95], v3 offset:128
    v_mfma_f32_16x16x32_bf16 a[24:27], v[48:51], v[72:75], a[24:27]
    v_mfma_f32_16x16x32_bf16 a[28:31], v[48:51], v[76:79], a[28:31]
    v_mfma_f32_16x16x32_bf16 a[20:23], v[52:55], v[64:67], a[20:23]
    v_mfma_f32_16x16x32_bf16 a[24:27], v[52:55], v[68:71], a[24:27]
    v_mfma_f32_16x16x32_bf16 a[28:31], v[52:55], v[72:75], a[28:31]
    v_mfma_f32_16x16x32_bf16 a[24:27], v[56:59], v[64:67], a[24:27]
    v_mfma_f32_16x16x32_bf16 a[28:31], v[56:59], v[68:71], a[28:31]
    v_mfma_f32_16x16x32_bf16 a[28:31], v[60:63], v[64:67], a[28:31]
    s_cmp_lg_u32 s86, 0
    s_cbranch_scc1 CX_16
    v_mfma_f32_16x16x32_bf16 a[0:3], v[36:39], v[16:19], a[0:3]
    v_mfma_f32_16x16x32_bf16 a[4:7], v[40:43], v[16:19], a[4:7]
    v_mfma_f32_16x16x32_bf16 a[8:11], v[44:47], v[16:19], a[8:11]
    v_mfma_f32_16x16x32_bf16 a[12:15], v[48:51], v[16:19], a[12:15]
    v_mfma_f32_16x16x32_bf16 a[16:19], v[52:55], v[16:19], a[16:19]
    v_mfma_f32_16x16x32_bf16 a[20:23], v[56:59], v[16:19], a[20:23]
    v_mfma_f32_16x16x32_bf16 a[24:27], v[60:63], v[16:19], a[24:27]
    v_mfma_f32_16x16x32_bf16 a[28:31], v[12:15], v[16:19], a[28:31]
CX_16:
    s_waitcnt lgkmcnt(0)
    v_mfma_f32_16x16x32_bf16 a[0:3], a[32:35], a[64:67], a[0:3]
    v_add_u32 v8, 256, v2
    v_mfma_f32_16x16x32_bf16 a[4:7], a[32:35], a[68:71], a[4:7]
    v_add_u32 v9, 1280, v2
    v_mfma_f32_16x16x32_bf16 a[8:11], a[32:35], a[72:75], a[8:11]
    v_add_u32 v10, 2304, v2
    v_mfma_f32_16x16x32_bf16 a[12:15], a[32:35], a[76:79], a[12:15]
    v_add_u32 v11, 3328, v2
    v_mfma_f32_16x16x32_bf16 a[16:19], a[32:35], a[80:83], a[16:19]
    ds_read2_b32 v[32:33], v8 offset0:0 offset1:1
    v_mfma_f32_16x16x32_bf16 a[20:23], a[32:35], a[84:87], a[20:23]
    ds_read2_b32 v[34:35], v8 offset0:2 offset1:3
    v_mfma_f32_16x16x32_bf16 a[24:27], a[32:35], a[88:91], a[24:27]
    ds_read_b128 v[64:67], v3 offset:3840
    v_mfma_f32_16x16x32_bf16 a[28:31], a[32:35], a[92:95], a[28:31]
    ds_read2_b32 v[36:37], v8 offset0:128 offset1:129
    v_mfma_f32_16x16x32_bf16 a[4:7], a[36:39], a[64:67], a[4:7]
    ds_read2_b32 v[38:39], v8 offset0:130 offset1:131
    v_mfma_f32_16x16x32_bf16 a[8:11], a[36:39], a[68:71], a[8:11]
    ds_read_b128 v[68:71], v3 offset:3328
    v_mfma_f32_16x16x32_bf16 a[12:15], a[36:39], a[72:75], a[12:15]
    ds_read2_b32 v[40:41], v9 offset0:0 offset1:1
    v_mfma_f32_16x16x32_bf16 a[16:19], a[36:39], a[76:79], a[16:19]
    ds_read2_b32 v[42:43], v9 offset0:2 offset1:3
    v_mfma_f32_16x16x32_bf16 a[20:23], a[36:39], a[80:83], a[20:23]
    ds_read_b128 v[72:75], v3 offset:2816
    v_mfma_f32_16x16x32_bf16 a[24:27], a[36:39], a[84:87], a[24:27]
    ds_read2_b32 v[44:45], v9 offset0:128 offset1:129
    v_mfma_f32_16x16x32_bf16 a[28:31], a[36:39], a[88:91], a[28:31]
    ds_read2_b32 v[46:47], v9 offset0:130 offset1:131
    v_mfma_f32_16x16x32_bf16 a[8:11], a[40:43], a[64:67], a[8:11]
    ds_read_b128 v[76:79], v3 offset:2304
    v_mfma_f32_16x16x32_bf16 a[12:15], a[40:43], a[68:71], a[12:15]
    ds_read2_b32 v[48:49], v10 offset0:0 offset1:1
    v_mfma_f32_16x16x32_bf16 a[16:19], a[40:43], a[72:75], a[16:19]
    ds_read2_b32 v[50:51], v10 offset0:2 offset1:3
    v_mfma_f32_16x16x32_bf16 a[20:23], a[40:43], a[76:79], a[20:23]
    ds_read_b128 v[80:83], v3 offset:1792
    v_mfma_f32_16x16x32_bf16 a[24:27], a[40:43], a[80:83], a[24:27]
    ds_read2_b32 v[52:53], v10 offset0:128 offset1:129
    v_mfma_f32_16x16x32_bf16 a[28:31], a[40:43], a[84:87], a[28:31]
    ds_read2_b32 v[54:55], v10 offset0:130 offset1:131
    v_mfma_f32_16x16x32_bf16 a[12:15], a[44:47], a[64:67], a[12:15]
    ds_read_b128 v[84:87], v3 offset:1280
    v_mfma_f32_16x16x32_bf16 a[16:19], a[44:47], a[68:71], a[16:19]
    ds_read2_b32 v[56:57], v11 offset0:0 offset1:1
    v_mfma_f32_16x16x32_bf16 a[20:23], a[44:47], a[72:75], a[20:23]
    ds_read2_b32 v[58:59], v11 offset0:2 offset1:3
    v_mfma_f32_16x16x32_bf16 a[24:27], a[44:47], a[76:79], a[24:27]
    ds_read_b128 v[88:91], v3 offset:768
    v_mfma_f32_16x16x32_bf16 a[28:31], a[44:47], a[80:83], a[28:31]
    ds_read2_b32 v[60:61], v11 offset0:128 offset1:129
    v_mfma_f32_16x16x32_bf16 a[16:19], a[48:51], a[64:67], a[16:19]
    ds_read2_b32 v[62:63], v11 offset0:130 offset1:131
    v_mfma_f32_16x16x32_bf16 a[20:23], a[48:51], a[68:71], a[20:23]
    ds_read_b128 v[92:95], v3 offset:256
    v_mfma_f32_16x16x32_bf16 a[24:27], a[48:51], a[72:75], a[24:27]
    v_mfma_f32_16x16x32_bf16 a[28:31], a[48:51], a[76:79], a[28:31]
    v_mfma_f32_16x16x32_bf16 a[20:23], a[52:55], a[64:67], a[20:23]
    v_mfma_f32_16x16x32_bf16 a[24:27], a[52:55], a[68:71], a[24:27]
    v_mfma_f32_16x16x32_bf16 a[28:31], a[52:55], a[72:75], a[28:31]
    v_mfma_f32_16x16x32_bf16 a[24:27], a[56:59], a[64:67], a[24:27]
    v_mfma_f32_16x16x32_bf16 a[28:31], a[56:59], a[68:71], a[28:31]
    v_mfma_f32_16x16x32_bf16 a[28:31], a[60:63], a[64:67], a[28:31]
    s_waitcnt lgkmcnt(0)
    v_mfma_f32_16x16x32_bf16 a[0:3], v[32:35], v[64:67], a[0:3]
    v_add_u32 v8, 384, v2
    v_mfma_f32_16x16x32_bf16 a[4:7], v[32:35], v[68:71], a[4:7]
    v_add_u32 v9, 1408, v2
    v_mfma_f32_16x16x32_bf16 a[8:11], v[32:35], v[72:75], a[8:11]
    v_add_u32 v10, 2432, v2
    v_mfma_f32_16x16x32_bf16 a[12:15], v[32:35], v[76:79], a[12:15]
    v_add_u32 v11, 3456, v2
    v_mfma_f32_16x16x32_bf16 a[16:19], v[32:35], v[80:83], a[16:19]
    ds_read2_b32 a[32:33], v8 offset0:0 offset1:1
    v_mfma_f32_16x16x32_bf16 a[20:23], v[32:35], v[84:87], a[20:23]
    ds_read2_b32 a[34:35], v8 offset0:2 offset1:3
    v_mfma_f32_16x16x32_bf16 a[24:27], v[32:35], v[88:91], a[24:27]
    ds_read_b128 a[64:67], v3 offset:3968
    v_mfma_f32_16x16x32_bf16 a[28:31], v[32:35], v[92:95], a[28:31]
    ds_read2_b32 a[36:37], v8 offset0:128 offset1:129
    v_mfma_f32_16x16x32_bf16 a[4:7], v[36:39], v[64:67], a[4:7]
    ds_read2_b32 a[38:39], v8 offset0:130 offset1:131
    v_mfma_f32_16x16x32_bf16 a[8:11], v[36:39], v[68:71], a[8:11]
    ds_read_b128 a[68:71], v3 offset:3456
    v_mfma_f32_16x16x32_bf16 a[12:15], v[36:39], v[72:75], a[12:15]
    ds_read2_b32 a[40:41], v9 offset0:0 offset1:1
    v_mfma_f32_16x16x32_bf16 a[16:19], v[36:39], v[76:79], a[16:19]
    ds_read2_b32 a[42:43], v9 offset0:2 offset1:3
    v_mfma_f32_16x16x32_bf16 a[20:23], v[36:39], v[80:83], a[20:23]
    ds_read_b128 a[72:75], v3 offset:2944
    v_mfma_f32_16x16x32_bf16 a[24:27], v[36:39], v[84:87], a[24:27]
    ds_read2_b32 a[44:45], v9 offset0:128 offset1:129
    v_mfma_f32_16x16x32_bf16 a[28:31], v[36:39], v[88:91], a[28:31]
    ds_read2_b32 a[46:47], v9 offset0:130 offset1:131
    v_mfma_f32_16x16x32_bf16 a[8:11], v[40:43], v[64:67], a[8:11]
    ds_read_b128 a[76:79], v3 offset:2432
    v_mfma_f32_16x16x32_bf16 a[12:15], v[40:43], v[68:71], a[12:15]
    ds_read2_b32 a[48:49], v10 offset0:0 offset1:1
    v_mfma_f32_16x16x32_bf16 a[16:19], v[40:43], v[72:75], a[16:19]
    ds_read2_b32 a[50:51], v10 offset0:2 offset1:3
    v_mfma_f32_16x16x32_bf16 a[20:23], v[40:43], v[76:79], a[20:23]
    ds_read_b128 a[80:83], v3 offset:1920
    v_mfma_f32_16x16x32_bf16 a[24:27], v[40:43], v[80:83], a[24:27]
    ds_read2_b32 a[52:53], v10 offset0:128 offset1:129
    v_mfma_f32_16x16x32_bf16 a[28:31], v[40:43], v[84:87], a[28:31]
    ds_read2_b32 a[54:55], v10 offset0:130 offset1:131
    v_mfma_f32_16x16x32_bf16 a[12:15], v[44:47], v[64:67], a[12:15]
    ds_read_b128 a[84:87], v3 offset:1408
    v_mfma_f32_16x16x32_bf16 a[16:19], v[44:47], v[68:71], a[16:19]
    ds_read2_b32 a[56:57], v11 offset0:0 offset1:1
    v_mfma_f32_16x16x32_bf16 a[20:23], v[44:47], v[72:75], a[20:23]
    ds_read2_b32 a[58:59], v11 offset0:2 offset1:3
    v_mfma_f32_16x16x32_bf16 a[24:27], v[44:47], v[76:79], a[24:27]
    ds_read_b128 a[88:91], v3 offset:896
    v_mfma_f32_16x16x32_bf16 a[28:31], v[44:47], v[80:83], a[28:31]
    ds_read2_b32 a[60:61], v11 offset0:128 offset1:129
    v_mfma_f32_16x16x32_bf16 a[16:19], v[48:51], v[64:67], a[16:19]
    ds_read2_b32 a[62:63], v11 offset0:130 offset1:131
    v_mfma_f32_16x16x32_bf16 a[20:23], v[48:51], v[68:71], a[20:23]
    ds_read_b128 a[92:95], v3 offset:384
    v_mfma_f32_16x16x32_bf16 a[24:27], v[48:51], v[72:75], a[24:27]
    v_mfma_f32_16x16x32_bf16 a[28:31], v[48:51], v[76:79], a[28:31]
    v_mfma_f32_16x16x32_bf16 a[20:23], v[52:55], v[64:67], a[20:23]
    v_mfma_f32_16x16x32_bf16 a[24:27], v[52:55], v[68:71], a[24:27]
    v_mfma_f32_16x16x32_bf16 a[28:31], v[52:55], v[72:75], a[28:31]
    v_mfma_f32_16x16x32_bf16 a[24:27], v[56:59], v[64:67], a[24:27]
    v_mfma_f32_16x16x32_bf16 a[28:31], v[56:59], v[68:71], a[28:31]
    v_mfma_f32_16x16x32_bf16 a[28:31], v[60:63], v[64:67], a[28:31]
    s_waitcnt lgkmcnt(0)
    v_mfma_f32_16x16x32_bf16 a[0:3], a[32:35], a[64:67], a[0:3]
    v_mfma_f32_16x16x32_bf16 a[4:7], a[32:35], a[68:71], a[4:7]
    v_mfma_f32_16x16x32_bf16 a[8:11], a[32:35], a[72:75], a[8:11]
    v_mfma_f32_16x16x32_bf16 a[12:15], a[32:35], a[76:79], a[12:15]
    v_mfma_f32_16x16x32_bf16 a[16:19], a[32:35], a[80:83], a[16:19]
    v_mfma_f32_16x16x32_bf16 a[20:23], a[32:35], a[84:87], a[20:23]
    v_mfma_f32_16x16x32_bf16 a[24:27], a[32:35], a[88:91], a[24:27]
    v_mfma_f32_16x16x32_bf16 a[28:31], a[32:35], a[92:95], a[28:31]
    v_mfma_f32_16x16x32_bf16 a[4:7], a[36:39], a[64:67], a[4:7]
    v_mfma_f32_16x16x32_bf16 a[8:11], a[36:39], a[68:71], a[8:11]
    v_mfma_f32_16x16x32_bf16 a[12:15], a[36:39], a[72:75], a[12:15]
    v_mfma_f32_16x16x32_bf16 a[16:19], a[36:39], a[76:79], a[16:19]
    v_mfma_f32_16x16x32_bf16 a[20:23], a[36:39], a[80:83], a[20:23]
    v_mfma_f32_16x16x32_bf16 a[24:27], a[36:39], a[84:87], a[24:27]
    v_mfma_f32_16x16x32_bf16 a[28:31], a[36:39], a[88:91], a[28:31]
    v_mfma_f32_16x16x32_bf16 a[8:11], a[40:43], a[64:67], a[8:11]
    v_mfma_f32_16x16x32_bf16 a[12:15], a[40:43], a[68:71], a[12:15]
    v_mfma_f32_16x16x32_bf16 a[16:19], a[40:43], a[72:75], a[16:19]
    v_mfma_f32_16x16x32_bf16 a[20:23], a[40:43], a[76:79], a[20:23]
    v_mfma_f32_16x16x32_bf16 a[24:27], a[40:43], a[80:83], a[24:27]
    v_mfma_f32_16x16x32_bf16 a[28:31], a[40:43], a[84:87], a[28:31]
    v_mfma_f32_16x16x32_bf16 a[12:15], a[44:47], a[64:67], a[12:15]
    v_mfma_f32_16x16x32_bf16 a[16:19], a[44:47], a[68:71], a[16:19]
    v_mfma_f32_16x16x32_bf16 a[20:23], a[44:47], a[72:75], a[20:23]
    v_mfma_f32_16x16x32_bf16 a[24:27], a[44:47], a[76:79], a[24:27]
    v_mfma_f32_16x16x32_bf16 a[28:31], a[44:47], a[80:83], a[28:31]
    v_mfma_f32_16x16x32_bf16 a[16:19], a[48:51], a[64:67], a[16:19]
    v_mfma_f32_16x16x32_bf16 a[20:23], a[48:51], a[68:71], a[20:23]
    v_mfma_f32_16x16x32_bf16 a[24:27], a[48:51], a[72:75], a[24:27]
    v_mfma_f32_16x16x32_bf16 a[28:31], a[48:51], a[76:79], a[28:31]
    v_mfma_f32_16x16x32_bf16 a[20:23], a[52:55], a[64:67], a[20:23]
    v_mfma_f32_16x16x32_bf16 a[24:27], a[52:55], a[68:71], a[24:27]
    v_mfma_f32_16x16x32_bf16 a[28:31], a[52:55], a[72:75], a[28:31]
    v_mfma_f32_16x16x32_bf16 a[24:27], a[56:59], a[64:67], a[24:27]
    v_mfma_f32_16x16x32_bf16 a[28:31], a[56:59], a[68:71], a[28:31]
    v_mfma_f32_16x16x32_bf16 a[28:31], a[60:63], a[64:67], a[28:31]
    s_lshl_b32 s84, s87, 12
    s_add_u32 s84, s84, 98304
    v_lshlrev_b32 v8, 4, v1
    v_add_u32 v9, s84, v8
    s_xor_b32 s84, s87, 1
    s_lshl_b32 s84, s84, 12
    s_add_u32 s84, s84, 98304
    v_add_u32 v10, s84, v8
    s_cmp_eq_u32 s86, 0
    s_cselect_b64 vcc, -1, 0
    v_accvgpr_read_b32 v64, a0
    v_accvgpr_read_b32 v80, a16
    v_accvgpr_read_b32 v65, a1
    v_accvgpr_read_b32 v81, a17
    v_accvgpr_read_b32 v66, a2
    v_accvgpr_read_b32 v82, a18
    v_accvgpr_read_b32 v67, a3
    v_accvgpr_read_b32 v83, a19
    v_accvgpr_read_b32 v68, a4
    v_accvgpr_read_b32 v84, a20
    v_accvgpr_read_b32 v69, a5
    v_accvgpr_read_b32 v85, a21
    v_accvgpr_read_b32 v70, a6
    v_accvgpr_read_b32 v86, a22
    v_accvgpr_read_b32 v71, a7
    v_accvgpr_read_b32 v87, a23
    v_accvgpr_read_b32 v72, a8
    v_accvgpr_read_b32 v88, a24
    v_accvgpr_read_b32 v73, a9
    v_accvgpr_read_b32 v89, a25
    v_accvgpr_read_b32 v74, a10
    v_accvgpr_read_b32 v90, a26
    v_accvgpr_read_b32 v75, a11
    v_accvgpr_read_b32 v91, a27
    v_accvgpr_read_b32 v76, a12
    v_accvgpr_read_b32 v92, a28
    v_accvgpr_read_b32 v77, a13
    v_accvgpr_read_b32 v93, a29
    v_accvgpr_read_b32 v78, a14
    v_accvgpr_read_b32 v94, a30
    v_accvgpr_read_b32 v79, a15
    v_accvgpr_read_b32 v95, a31
    v_cndmask_b32 v32, v64, v80, vcc
    v_cndmask_b32 v48, v80, v64, vcc
    v_cndmask_b32 v33, v65, v81, vcc
    v_cndmask_b32 v49, v81, v65, vcc
    v_cndmask_b32 v34, v66, v82, vcc
    v_cndmask_b32 v50, v82, v66, vcc
    v_cndmask_b32 v35, v67, v83, vcc
    v_cndmask_b32 v51, v83, v67, vcc
    v_cndmask_b32 v36, v68, v84, vcc
    v_cndmask_b32 v52, v84, v68, vcc
    v_cndmask_b32 v37, v69, v85, vcc
    v_cndmask_b32 v53, v85, v69, vcc
    v_cndmask_b32 v38, v70, v86, vcc
    v_cndmask_b32 v54, v86, v70, vcc
    v_cndmask_b32 v39, v71, v87, vcc
    v_cndmask_b32 v55, v87, v71, vcc
    v_cndmask_b32 v40, v72, v88, vcc
    v_cndmask_b32 v56, v88, v72, vcc
    v_cndmask_b32 v41, v73, v89, vcc
    v_cndmask_b32 v57, v89, v73, vcc
    v_cndmask_b32 v42, v74, v90, vcc
    v_cndmask_b32 v58, v90, v74, vcc
    v_cndmask_b32 v43, v75, v91, vcc
    v_cndmask_b32 v59, v91, v75, vcc
    v_cndmask_b32 v44, v76, v92, vcc
    v_cndmask_b32 v60, v92, v76, vcc
    v_cndmask_b32 v45, v77, v93, vcc
    v_cndmask_b32 v61, v93, v77, vcc
    v_cndmask_b32 v46, v78, v94, vcc
    v_cndmask_b32 v62, v94, v78, vcc
    v_cndmask_b32 v47, v79, v95, vcc
    v_cndmask_b32 v63, v95, v79, vcc
    ds_write_b128 v9, v[32:35] offset:0
    ds_write_b128 v9, v[36:39] offset:1024
    ds_write_b128 v9, v[40:43] offset:2048
    ds_write_b128 v9, v[44:47] offset:3072
    v_lshlrev_b32 v11, 3, v5
    v_lshl_add_u32 v11, v4, 5, v11
    s_lshl_b32 s84, s86, 11
    v_add_u32 v11, s84, v11
    s_add_u32 s84, s91, 64
    v_add_u32 v14, s84, v11
    ds_read_b64 v[64:65], v14 offset:0
    ds_read_b64 v[66:67], v14 offset:512
    ds_read_b64 v[68:69], v14 offset:1024
    ds_read_b64 v[70:71], v14 offset:1536
    s_waitcnt lgkmcnt(0)
    v_mov_b32 v12, s89
    v_mov_b32 v13, 1
    s_mov_b64 exec, 1
    ds_add_u32 v12, v13
    s_mov_b64 exec, -1
SYNC_17:
    ds_read_b32 v13, v12
    s_waitcnt lgkmcnt(0)
    v_readfirstlane_b32 s84, v13
    s_nop 0
    s_cmp_ge_u32 s84, 8
    s_cbranch_scc0 SYNC_17
    ds_read_b128 v[32:35], v10 offset:0
    ds_read_b128 v[36:39], v10 offset:1024
    ds_read_b128 v[40:43], v10 offset:2048
    ds_read_b128 v[44:47], v10 offset:3072
    s_waitcnt vmcnt(0) lgkmcnt(0)
    v_add_f32 v48, v48, v32
    v_add_f32 v49, v49, v33
    v_cvt_pk_bf16_f32 v48, v48, v49
    v_lshlrev_b32 v32, 16, v64
    v_and_b32 v33, 0xffff0000, v64
    v_mul_f32 v32, v32, v99
    v_mul_f32 v33, v33, v99
    v_cvt_pk_bf16_f32 v32, v32, v33
    v_lshlrev_b32 v49, 16, v48
    v_and_b32 v48, 0xffff0000, v48
    v_lshlrev_b32 v33, 16, v32
    v_and_b32 v32, 0xffff0000, v32
    v_add_f32 v49, v49, v33
    v_add_f32 v48, v48, v32
    v_cvt_pk_bf16_f32 v64, v49, v48
    v_add_f32 v50, v50, v34
    v_add_f32 v51, v51, v35
    v_cvt_pk_bf16_f32 v50, v50, v51
    v_lshlrev_b32 v34, 16, v65
    v_and_b32 v35, 0xffff0000, v65
    v_mul_f32 v34, v34, v99
    v_mul_f32 v35, v35, v99
    v_cvt_pk_bf16_f32 v34, v34, v35
    v_lshlrev_b32 v51, 16, v50
    v_and_b32 v50, 0xffff0000, v50
    v_lshlrev_b32 v35, 16, v34
    v_and_b32 v34, 0xffff0000, v34
    v_add_f32 v51, v51, v35
    v_add_f32 v50, v50, v34
    v_cvt_pk_bf16_f32 v65, v51, v50
    buffer_store_dwordx2 v[64:65], v11, s[68:71], 0 offen offset:0 sc1
    v_add_f32 v52, v52, v36
    v_add_f32 v53, v53, v37
    v_cvt_pk_bf16_f32 v52, v52, v53
    v_lshlrev_b32 v36, 16, v66
    v_and_b32 v37, 0xffff0000, v66
    v_mul_f32 v36, v36, v99
    v_mul_f32 v37, v37, v99
    v_cvt_pk_bf16_f32 v36, v36, v37
    v_lshlrev_b32 v53, 16, v52
    v_and_b32 v52, 0xffff0000, v52
    v_lshlrev_b32 v37, 16, v36
    v_and_b32 v36, 0xffff0000, v36
    v_add_f32 v53, v53, v37
    v_add_f32 v52, v52, v36
    v_cvt_pk_bf16_f32 v66, v53, v52
    v_add_f32 v54, v54, v38
    v_add_f32 v55, v55, v39
    v_cvt_pk_bf16_f32 v54, v54, v55
    v_lshlrev_b32 v38, 16, v67
    v_and_b32 v39, 0xffff0000, v67
    v_mul_f32 v38, v38, v99
    v_mul_f32 v39, v39, v99
    v_cvt_pk_bf16_f32 v38, v38, v39
    v_lshlrev_b32 v55, 16, v54
    v_and_b32 v54, 0xffff0000, v54
    v_lshlrev_b32 v39, 16, v38
    v_and_b32 v38, 0xffff0000, v38
    v_add_f32 v55, v55, v39
    v_add_f32 v54, v54, v38
    v_cvt_pk_bf16_f32 v67, v55, v54
    buffer_store_dwordx2 v[66:67], v11, s[68:71], 0 offen offset:512 sc1
    v_add_f32 v56, v56, v40
    v_add_f32 v57, v57, v41
    v_cvt_pk_bf16_f32 v56, v56, v57
    v_lshlrev_b32 v40, 16, v68
    v_and_b32 v41, 0xffff0000, v68
    v_mul_f32 v40, v40, v99
    v_mul_f32 v41, v41, v99
    v_cvt_pk_bf16_f32 v40, v40, v41
    v_lshlrev_b32 v57, 16, v56
    v_and_b32 v56, 0xffff0000, v56
    v_lshlrev_b32 v41, 16, v40
    v_and_b32 v40, 0xffff0000, v40
    v_add_f32 v57, v57, v41
    v_add_f32 v56, v56, v40
    v_cvt_pk_bf16_f32 v68, v57, v56
    v_add_f32 v58, v58, v42
    v_add_f32 v59, v59, v43
    v_cvt_pk_bf16_f32 v58, v58, v59
    v_lshlrev_b32 v42, 16, v69
    v_and_b32 v43, 0xffff0000, v69
    v_mul_f32 v42, v42, v99
    v_mul_f32 v43, v43, v99
    v_cvt_pk_bf16_f32 v42, v42, v43
    v_lshlrev_b32 v59, 16, v58
    v_and_b32 v58, 0xffff0000, v58
    v_lshlrev_b32 v43, 16, v42
    v_and_b32 v42, 0xffff0000, v42
    v_add_f32 v59, v59, v43
    v_add_f32 v58, v58, v42
    v_cvt_pk_bf16_f32 v69, v59, v58
    buffer_store_dwordx2 v[68:69], v11, s[68:71], 0 offen offset:1024 sc1
    v_add_f32 v60, v60, v44
    v_add_f32 v61, v61, v45
    v_cvt_pk_bf16_f32 v60, v60, v61
    v_lshlrev_b32 v44, 16, v70
    v_and_b32 v45, 0xffff0000, v70
    v_mul_f32 v44, v44, v99
    v_mul_f32 v45, v45, v99
    v_cvt_pk_bf16_f32 v44, v44, v45
    v_lshlrev_b32 v61, 16, v60
    v_and_b32 v60, 0xffff0000, v60
    v_lshlrev_b32 v45, 16, v44
    v_and_b32 v44, 0xffff0000, v44
    v_add_f32 v61, v61, v45
    v_add_f32 v60, v60, v44
    v_cvt_pk_bf16_f32 v70, v61, v60
    v_add_f32 v62, v62, v46
    v_add_f32 v63, v63, v47
    v_cvt_pk_bf16_f32 v62, v62, v63
    v_lshlrev_b32 v46, 16, v71
    v_and_b32 v47, 0xffff0000, v71
    v_mul_f32 v46, v46, v99
    v_mul_f32 v47, v47, v99
    v_cvt_pk_bf16_f32 v46, v46, v47
    v_lshlrev_b32 v63, 16, v62
    v_and_b32 v62, 0xffff0000, v62
    v_lshlrev_b32 v47, 16, v46
    v_and_b32 v46, 0xffff0000, v46
    v_add_f32 v63, v63, v47
    v_add_f32 v62, v62, v46
    v_cvt_pk_bf16_f32 v71, v63, v62
    buffer_store_dwordx2 v[70:71], v11, s[68:71], 0 offen offset:1536 sc1
    v_mov_b32 v12, 152264
LNON_18:
    ds_read_b64 v[14:15], v12
    s_waitcnt lgkmcnt(0)
    v_readfirstlane_b32 s12, v14
    v_readfirstlane_b32 s13, v15
    s_cmp_lg_u32 s12, 0
    s_cbranch_scc0 LNON_18
    s_waitcnt vmcnt(0)
    v_mov_b32 v12, 152276
    v_mov_b32 v13, 1
    s_mov_b64 exec, 1
    ds_add_rtn_u32 v13, v12, v13
    s_mov_b64 exec, -1
    s_waitcnt lgkmcnt(0)
    v_readfirstlane_b32 s84, v13
    s_nop 0
    s_cmp_lg_u32 s84, 3
    s_cbranch_scc1 ASIG_19
    s_add_u32 s82, s2, 512
    s_lshl_b32 s82, s82, 7
    v_mov_b32 v3, s82
    v_mov_b32 v4, s12
    v_mov_b32 v5, s13
    s_mov_b64 exec, 1
    buffer_store_dwordx2 v[4:5], v3, s[8:11], 0 offen sc0 sc1
    s_mov_b64 exec, -1
ASIG_19:
    s_branch L_END
L_GPATH:
    s_lshl_b32 s80, s2, 3
    s_and_b32 s81, s3, 3
    s_lshl_b32 s81, s81, 1
    s_add_u32 s80, s80, s81
    s_add_u32 s80, s80, 0
    s_mul_i32 s81, s80, 896
    v_lshlrev_b32 v2, 4, v1
    v_add_u32 v2, s81, v2
    v_mov_b32 v3, 0x7f000000
    v_cmp_gt_u32 vcc, 56, v1
    s_nop 1
    v_cndmask_b32 v2, v3, v2, vcc
    buffer_load_dwordx4 v[4:7], v2, s[48:51], 0 offen
    buffer_load_dwordx4 v[36:39], v2, s[48:51], 0 offen offset:896
    s_and_b32 s80, s2, 7
    s_lshr_b32 s81, s2, 3
    s_mul_i32 s82, s81, 37
    s_lshr_b32 s82, s82, 8
    s_mul_i32 s83, s82, 7
    s_sub_u32 s83, s81, s83
    s_lshr_b32 s84, s80, 1
    s_lshl_b32 s85, s84, 2
    s_add_u32 s85, s85, s82
    s_and_b32 s84, s80, 1
    s_mul_i32 s86, s84, 7
    s_add_u32 s86, s86, s83
    s_lshl_b32 s87, s80, 2
    s_add_u32 s87, s87, s82
    s_mov_b32 s88, s83
    s_cmp_lt_u32 s3, 2
    s_cselect_b32 s64, s36, s38
    s_cselect_b32 s65, s37, s39
    s_mov_b32 s66, 1605632
    s_mov_b32 s67, 0x00020000
    v_lshrrev_b32 v26, 3, v1
    v_and_b32 v27, 7, v1
    v_lshrrev_b32 v28, 1, v27
    v_bfe_u32 v29, v1, 4, 1
    v_lshlrev_b32 v29, 1, v29
    v_xor_b32 v28, v28, v29
    v_and_b32 v27, 1, v27
    v_lshl_add_u32 v28, v28, 1, v27
    v_lshlrev_b32 v28, 4, v28
    v_mul_u32_u24 v26, 3584, v26
    v_add_u32 v30, v26, v28
    s_lshl_b32 s80, s86, 8
    s_and_b32 s81, s3, 1
    s_mul_i32 s81, s81, 114688
    s_add_u32 s80, s80, s81
    v_add_u32 v30, s80, v30
    s_lshl_b32 s89, s3, 12
    s_cmp_lt_u32 s2, 224
    s_cbranch_scc1 NW_20
    s_mov_b32 s66, 0
NW_20:
    s_add_u32 m0, s89, 0
    s_mov_b32 s80, 0
    buffer_load_dwordx4 v30, s[64:67], s80 offen lds
    s_add_u32 m0, s89, 1024
    s_mov_b32 s80, 28672
    buffer_load_dwordx4 v30, s[64:67], s80 offen lds
    s_add_u32 m0, s89, 2048
    s_mov_b32 s80, 57344
    buffer_load_dwordx4 v30, s[64:67], s80 offen lds
    s_add_u32 m0, s89, 3072
    s_mov_b32 s80, 86016
    buffer_load_dwordx4 v30, s[64:67], s80 offen lds
    s_add_u32 m0, s89, 16384
    s_mov_b32 s80, 229376
    buffer_load_dwordx4 v30, s[64:67], s80 offen lds
    s_add_u32 m0, s89, 17408
    s_mov_b32 s80, 258048
    buffer_load_dwordx4 v30, s[64:67], s80 offen lds
    s_add_u32 m0, s89, 18432
    s_mov_b32 s80, 286720
    buffer_load_dwordx4 v30, s[64:67], s80 offen lds
    s_add_u32 m0, s89, 19456
    s_mov_b32 s80, 315392
    buffer_load_dwordx4 v30, s[64:67], s80 offen lds
    s_add_u32 m0, s89, 32768
    s_mov_b32 s80, 458752
    buffer_load_dwordx4 v30, s[64:67], s80 offen lds
    s_add_u32 m0, s89, 33792
    s_mov_b32 s80, 487424
    buffer_load_dwordx4 v30, s[64:67], s80 offen lds
    s_add_u32 m0, s89, 34816
    s_mov_b32 s80, 516096
    buffer_load_dwordx4 v30, s[64:67], s80 offen lds
    s_add_u32 m0, s89, 35840
    s_mov_b32 s80, 544768
    buffer_load_dwordx4 v30, s[64:67], s80 offen lds
    s_waitcnt lgkmcnt(0)
    s_barrier
    s_setprio 3
    s_and_b32 s81, s3, 3
    s_lshl_b32 s81, s81, 2
    s_add_u32 s81, s81, 65536
    v_mul_u32_u24 v3, 144, v1
    v_add_u32 v3, s81, v3
    v_cmp_gt_u32 vcc, 56, v1
    v_mov_b32 v24, 991054117
    v_mov_b32 v25, 0x43e00000
    s_waitcnt vmcnt(12)
    v_lshlrev_b32 v8, 16, v4
    v_and_b32 v9, 0xffff0000, v4
    v_lshlrev_b32 v10, 16, v5
    v_and_b32 v11, 0xffff0000, v5
    v_lshlrev_b32 v12, 16, v6
    v_and_b32 v13, 0xffff0000, v6
    v_lshlrev_b32 v14, 16, v7
    v_and_b32 v15, 0xffff0000, v7
    v_add_f32 v16, v8, v9
    v_add_f32 v17, v10, v11
    v_add_f32 v18, v12, v13
    v_add_f32 v19, v14, v15
    v_add_f32 v16, v16, v17
    v_add_f32 v18, v18, v19
    v_add_f32 v16, v16, v18
    s_nop 1
    v_add_f32_dpp v17, v16, v16 quad_perm:[1,0,3,2] row_mask:0xf bank_mask:0xf
    s_nop 1
    v_add_f32_dpp v16, v17, v17 quad_perm:[2,3,0,1] row_mask:0xf bank_mask:0xf
    s_nop 1
    v_add_f32_dpp v17, v16, v16 row_half_mirror row_mask:0xf bank_mask:0xf
    s_nop 1
    v_add_f32_dpp v16, v17, v17 row_mirror row_mask:0xf bank_mask:0xf
    s_nop 0
    v_readlane_b32 s80, v16, 0
    v_readlane_b32 s81, v16, 16
    v_readlane_b32 s82, v16, 32
    v_readlane_b32 s83, v16, 48
    v_mov_b32 v16, s80
    v_add_f32 v16, s81, v16
    v_add_f32 v16, s82, v16
    v_add_f32 v16, s83, v16
    v_mul_f32 v17, v16, v24
    v_fma_f32 v18, -v17, v25, v16
    v_fma_f32 v17, v18, v24, v17
    v_mov_b32 v18, 0
    v_sub_f32 v19, v8, v17
    v_fmac_f32 v18, v19, v19
    v_sub_f32 v19, v9, v17
    v_fmac_f32 v18, v19, v19
    v_sub_f32 v19, v10, v17
    v_fmac_f32 v18, v19, v19
    v_sub_f32 v19, v11, v17
    v_fmac_f32 v18, v19, v19
    v_sub_f32 v19, v12, v17
    v_fmac_f32 v18, v19, v19
    v_sub_f32 v19, v13, v17
    v_fmac_f32 v18, v19, v19
    v_sub_f32 v19, v14, v17
    v_fmac_f32 v18, v19, v19
    v_sub_f32 v19, v15, v17
    v_fmac_f32 v18, v19, v19
    v_mov_b32 v19, 0
    v_cndmask_b32 v18, v19, v18, vcc
    s_nop 1
    v_add_f32_dpp v19, v18, v18 quad_perm:[1,0,3,2] row_mask:0xf bank_mask:0xf
    s_nop 1
    v_add_f32_dpp v18, v19, v19 quad_perm:[2,3,0,1] row_mask:0xf bank_mask:0xf
    s_nop 1
    v_add_f32_dpp v19, v18, v18 row_half_mirror row_mask:0xf bank_mask:0xf
    s_nop 1
    v_add_f32_dpp v18, v19, v19 row_mirror row_mask:0xf bank_mask:0xf
    s_nop 0
    v_readlane_b32 s80, v18, 0
    v_readlane_b32 s81, v18, 16
    v_readlane_b32 s82, v18, 32
    v_readlane_b32 s83, v18, 48
    v_mov_b32 v18, s80
    v_add_f32 v18, s81, v18
    v_add_f32 v18, s82, v18
    v_add_f32 v18, s83, v18
    v_mul_f32 v19, v18, v24
    v_fma_f32 v20, -v19, v25, v18
    v_fma_f32 v19, v20, v24, v19
    v_cvt_pk_bf16_f32 v17, v17, v19
    v_and_b32 v19, 0xffff0000, v17
    v_lshlrev_b32 v17, 16, v17
    v_add_f32 v19, 925353388, v19
    v_cvt_pk_bf16_f32 v19, v19, v19
    v_lshlrev_b32 v19, 16, v19
    v_sqrt_f32 v19, v19
    s_nop 0
    v_cvt_pk_bf16_f32 v19, v19, v19
    v_lshlrev_b32 v19, 16, v19
    v_rcp_f32 v19, v19
    v_sub_f32 v8, v8, v17
    v_sub_f32 v9, v9, v17
    v_cvt_pk_bf16_f32 v4, v8, v9
    v_lshlrev_b32 v8, 16, v4
    v_and_b32 v9, 0xffff0000, v4
    v_mul_f32 v8, v8, v19
    v_mul_f32 v9, v9, v19
    v_cvt_pk_bf16_f32 v20, v8, v9
    v_sub_f32 v10, v10, v17
    v_sub_f32 v11, v11, v17
    v_cvt_pk_bf16_f32 v5, v10, v11
    v_lshlrev_b32 v10, 16, v5
    v_and_b32 v11, 0xffff0000, v5
    v_mul_f32 v10, v10, v19
    v_mul_f32 v11, v11, v19
    v_cvt_pk_bf16_f32 v21, v10, v11
    v_sub_f32 v12, v12, v17
    v_sub_f32 v13, v13, v17
    v_cvt_pk_bf16_f32 v6, v12, v13
    v_lshlrev_b32 v12, 16, v6
    v_and_b32 v13, 0xffff0000, v6
    v_mul_f32 v12, v12, v19
    v_mul_f32 v13, v13, v19
    v_cvt_pk_bf16_f32 v22, v12, v13
    v_sub_f32 v14, v14, v17
    v_sub_f32 v15, v15, v17
    v_cvt_pk_bf16_f32 v7, v14, v15
    v_lshlrev_b32 v14, 16, v7
    v_and_b32 v15, 0xffff0000, v7
    v_mul_f32 v14, v14, v19
    v_mul_f32 v15, v15, v19
    v_cvt_pk_bf16_f32 v23, v14, v15
    buffer_store_dwordx4 v[20:23], v2, s[52:55], 0 offen offset:0 sc1
    ds_write_b16 v3, v20 offset:0
    ds_write_b16_d16_hi v3, v20 offset:16
    ds_write_b16 v3, v21 offset:32
    ds_write_b16_d16_hi v3, v21 offset:48
    ds_write_b16 v3, v22 offset:64
    ds_write_b16_d16_hi v3, v22 offset:80
    ds_write_b16 v3, v23 offset:96
    ds_write_b16_d16_hi v3, v23 offset:112
    v_lshlrev_b32 v8, 16, v36
    v_and_b32 v9, 0xffff0000, v36
    v_lshlrev_b32 v10, 16, v37
    v_and_b32 v11, 0xffff0000, v37
    v_lshlrev_b32 v12, 16, v38
    v_and_b32 v13, 0xffff0000, v38
    v_lshlrev_b32 v14, 16, v39
    v_and_b32 v15, 0xffff0000, v39
    v_add_f32 v16, v8, v9
    v_add_f32 v17, v10, v11
    v_add_f32 v18, v12, v13
    v_add_f32 v19, v14, v15
    v_add_f32 v16, v16, v17
    v_add_f32 v18, v18, v19
    v_add_f32 v16, v16, v18
    s_nop 1
    v_add_f32_dpp v17, v16, v16 quad_perm:[1,0,3,2] row_mask:0xf bank_mask:0xf
    s_nop 1
    v_add_f32_dpp v16, v17, v17 quad_perm:[2,3,0,1] row_mask:0xf bank_mask:0xf
    s_nop 1
    v_add_f32_dpp v17, v16, v16 row_half_mirror row_mask:0xf bank_mask:0xf
    s_nop 1
    v_add_f32_dpp v16, v17, v17 row_mirror row_mask:0xf bank_mask:0xf
    s_nop 0
    v_readlane_b32 s80, v16, 0
    v_readlane_b32 s81, v16, 16
    v_readlane_b32 s82, v16, 32
    v_readlane_b32 s83, v16, 48
    v_mov_b32 v16, s80
    v_add_f32 v16, s81, v16
    v_add_f32 v16, s82, v16
    v_add_f32 v16, s83, v16
    v_mul_f32 v17, v16, v24
    v_fma_f32 v18, -v17, v25, v16
    v_fma_f32 v17, v18, v24, v17
    v_mov_b32 v18, 0
    v_sub_f32 v19, v8, v17
    v_fmac_f32 v18, v19, v19
    v_sub_f32 v19, v9, v17
    v_fmac_f32 v18, v19, v19
    v_sub_f32 v19, v10, v17
    v_fmac_f32 v18, v19, v19
    v_sub_f32 v19, v11, v17
    v_fmac_f32 v18, v19, v19
    v_sub_f32 v19, v12, v17
    v_fmac_f32 v18, v19, v19
    v_sub_f32 v19, v13, v17
    v_fmac_f32 v18, v19, v19
    v_sub_f32 v19, v14, v17
    v_fmac_f32 v18, v19, v19
    v_sub_f32 v19, v15, v17
    v_fmac_f32 v18, v19, v19
    v_mov_b32 v19, 0
    v_cndmask_b32 v18, v19, v18, vcc
    s_nop 1
    v_add_f32_dpp v19, v18, v18 quad_perm:[1,0,3,2] row_mask:0xf bank_mask:0xf
    s_nop 1
    v_add_f32_dpp v18, v19, v19 quad_perm:[2,3,0,1] row_mask:0xf bank_mask:0xf
    s_nop 1
    v_add_f32_dpp v19, v18, v18 row_half_mirror row_mask:0xf bank_mask:0xf
    s_nop 1
    v_add_f32_dpp v18, v19, v19 row_mirror row_mask:0xf bank_mask:0xf
    s_nop 0
    v_readlane_b32 s80, v18, 0
    v_readlane_b32 s81, v18, 16
    v_readlane_b32 s82, v18, 32
    v_readlane_b32 s83, v18, 48
    v_mov_b32 v18, s80
    v_add_f32 v18, s81, v18
    v_add_f32 v18, s82, v18
    v_add_f32 v18, s83, v18
    v_mul_f32 v19, v18, v24
    v_fma_f32 v20, -v19, v25, v18
    v_fma_f32 v19, v20, v24, v19
    v_cvt_pk_bf16_f32 v17, v17, v19
    v_and_b32 v19, 0xffff0000, v17
    v_lshlrev_b32 v17, 16, v17
    v_add_f32 v19, 925353388, v19
    v_cvt_pk_bf16_f32 v19, v19, v19
    v_lshlrev_b32 v19, 16, v19
    v_sqrt_f32 v19, v19
    s_nop 0
    v_cvt_pk_bf16_f32 v19, v19, v19
    v_lshlrev_b32 v19, 16, v19
    v_rcp_f32 v19, v19
    v_sub_f32 v8, v8, v17
    v_sub_f32 v9, v9, v17
    v_cvt_pk_bf16_f32 v36, v8, v9
    v_lshlrev_b32 v8, 16, v36
    v_and_b32 v9, 0xffff0000, v36
    v_mul_f32 v8, v8, v19
    v_mul_f32 v9, v9, v19
    v_cvt_pk_bf16_f32 v40, v8, v9
    v_sub_f32 v10, v10, v17
    v_sub_f32 v11, v11, v17
    v_cvt_pk_bf16_f32 v37, v10, v11
    v_lshlrev_b32 v10, 16, v37
    v_and_b32 v11, 0xffff0000, v37
    v_mul_f32 v10, v10, v19
    v_mul_f32 v11, v11, v19
    v_cvt_pk_bf16_f32 v41, v10, v11
    v_sub_f32 v12, v12, v17
    v_sub_f32 v13, v13, v17
    v_cvt_pk_bf16_f32 v38, v12, v13
    v_lshlrev_b32 v12, 16, v38
    v_and_b32 v13, 0xffff0000, v38
    v_mul_f32 v12, v12, v19
    v_mul_f32 v13, v13, v19
    v_cvt_pk_bf16_f32 v42, v12, v13
    v_sub_f32 v14, v14, v17
    v_sub_f32 v15, v15, v17
    v_cvt_pk_bf16_f32 v39, v14, v15
    v_lshlrev_b32 v14, 16, v39
    v_and_b32 v15, 0xffff0000, v39
    v_mul_f32 v14, v14, v19
    v_mul_f32 v15, v15, v19
    v_cvt_pk_bf16_f32 v43, v14, v15
    buffer_store_dwordx4 v[40:43], v2, s[52:55], 0 offen offset:896 sc1
    ds_write_b16 v3, v40 offset:2
    ds_write_b16_d16_hi v3, v40 offset:18
    ds_write_b16 v3, v41 offset:34
    ds_write_b16_d16_hi v3, v41 offset:50
    ds_write_b16 v3, v42 offset:66
    ds_write_b16_d16_hi v3, v42 offset:82
    ds_write_b16 v3, v43 offset:98
    ds_write_b16_d16_hi v3, v43 offset:114
    s_waitcnt lgkmcnt(0)
    v_mov_b32 v4, 152192
    v_mov_b32 v5, 1
    s_mov_b64 exec, 1
    ds_add_u32 v4, v5
    s_mov_b64 exec, -1
SYNC_21:
    ds_read_b32 v5, v4
    s_waitcnt lgkmcnt(0)
    v_readfirstlane_b32 s84, v5
    s_nop 0
    s_cmp_ge_u32 s84, 4
    s_cbranch_scc0 SYNC_21
    v_lshrrev_b32 v3, 3, v0
    v_mul_u32_u24 v3, 144, v3
    v_and_b32 v4, 7, v0
    v_lshl_add_u32 v3, v4, 4, v3
    v_add_u32 v3, 65536, v3
    ds_read_b128 v[4:7], v3
    ds_read_b128 v[8:11], v3 offset:4608
    v_lshlrev_b32 v3, 4, v0
    s_mul_i32 s81, s2, 7168
    v_add_u32 v3, s81, v3
    v_mov_b32 v20, 0x7f000000
    v_cmp_gt_u32 vcc, 192, v0
    v_add_u32 v21, 4096, v3
    s_nop 0
    v_cndmask_b32 v21, v20, v21, vcc
    s_waitcnt lgkmcnt(0)
    buffer_store_dwordx4 v[4:7], v3, s[56:59], 0 offen sc1
    buffer_store_dwordx4 v[8:11], v21, s[56:59], 0 offen sc1
    s_nop 0
    v_mov_b32 v4, 152264
LNON_22:
    ds_read_b64 v[6:7], v4
    s_waitcnt lgkmcnt(0)
    v_readfirstlane_b32 s12, v6
    v_readfirstlane_b32 s13, v7
    s_cmp_lg_u32 s12, 0
    s_cbranch_scc0 LNON_22
    s_waitcnt vmcnt(2)
    v_mov_b32 v4, 152272
    v_mov_b32 v5, 1
    s_mov_b64 exec, 1
    ds_add_rtn_u32 v5, v4, v5
    s_mov_b64 exec, -1
    s_waitcnt lgkmcnt(0)
    v_readfirstlane_b32 s84, v5
    s_nop 0
    s_cmp_lg_u32 s84, 3
    s_cbranch_scc1 LS_23
    s_add_u32 s82, s2, 0
    s_lshl_b32 s82, s82, 7
    v_mov_b32 v4, s82
    v_mov_b32 v6, s12
    v_mov_b32 v7, s13
    s_mov_b64 exec, 1
    buffer_store_dwordx2 v[6:7], v4, s[8:11], 0 offen sc0 sc1
    s_mov_b64 exec, -1
LS_23:
    s_waitcnt vmcnt(0)
    v_mov_b32 v4, 152280
    v_mov_b32 v5, 1
    s_mov_b64 exec, 1
    ds_add_rtn_u32 v5, v4, v5
    s_mov_b64 exec, -1
    s_waitcnt lgkmcnt(0)
    v_readfirstlane_b32 s84, v5
    s_nop 0
    s_cmp_lg_u32 s84, 3
    s_cbranch_scc1 LS_24
    s_add_u32 s82, s2, 1024
    s_lshl_b32 s82, s82, 7
    v_mov_b32 v4, s82
    v_mov_b32 v6, s12
    v_mov_b32 v7, s13
    s_mov_b64 exec, 1
    buffer_store_dwordx2 v[6:7], v4, s[8:11], 0 offen sc0 sc1
    s_mov_b64 exec, -1
LS_24:
    s_waitcnt lgkmcnt(0)
    v_mov_b32 v4, 152192
    v_mov_b32 v5, 1
    s_mov_b64 exec, 1
    ds_add_u32 v4, v5
    s_mov_b64 exec, -1
SYNC_25:
    ds_read_b32 v5, v4
    s_waitcnt lgkmcnt(0)
    v_readfirstlane_b32 s84, v5
    s_nop 0
    s_cmp_ge_u32 s84, 8
    s_cbranch_scc0 SYNC_25
    s_cmp_ge_u32 s2, 224
    s_cbranch_scc1 L_END
    v_mov_b32 v2, 152212
    s_cmp_lg_u32 s3, 0
    s_cbranch_scc1 POLL_26_w
    s_lshl_b32 s80, s85, 4
    v_add_u32 v3, s80, v1
    v_mov_b32 v6, 2000
    v_cmp_gt_u32 vcc, 16, v1
    s_nop 1
    v_cndmask_b32 v3, v6, v3, vcc
    v_cmp_le_u32 vcc, 1280, v3
    s_nop 0
    s_mov_b64 s[14:15], vcc
    v_lshlrev_b32 v3, 7, v3
PL_27:
    buffer_load_dwordx2 v[6:7], v3, s[8:11], 0 offen sc0 sc1
    s_waitcnt vmcnt(0)
    v_cmp_eq_u32 vcc, s12, v6
    v_cmp_eq_u32 s[82:83], s13, v7
    s_nop 0
    s_and_b64 vcc, vcc, s[82:83]
    s_or_b64 vcc, vcc, s[14:15]
    s_cmp_eq_u64 vcc, -1
    s_cbranch_scc1 PL_27_ok
    s_sleep 2
    s_branch PL_27
PL_27_ok:
    v_mov_b32 v6, 1
    ds_write_b32 v2, v6
    s_branch POLL_26_done
POLL_26_w:
    ds_read_b32 v6, v2
    s_waitcnt lgkmcnt(0)
    v_readfirstlane_b32 s84, v6
    s_nop 0
    s_cmp_eq_u32 s84, 1
    s_cbranch_scc1 POLL_26_done
    s_sleep 1
    s_branch POLL_26_w
POLL_26_done:
    v_mov_b32 v2, v30
    s_lshl_b32 s80, s85, 7
    s_lshl_b32 s81, s3, 5
    s_add_u32 s80, s80, s81
    v_lshrrev_b32 v12, 3, v1
    v_add_u32 v13, s80, v12
    v_mul_u32_u24 v13, 896, v13
    v_lshrrev_b32 v12, 4, v1
    v_and_b32 v14, 7, v1
    v_xor_b32 v12, v12, v14
    v_lshl_add_u32 v3, v12, 4, v13
    v_xor_b32 v12, 4, v12
    v_lshl_add_u32 v4, v12, 4, v13
    s_add_u32 m0, s89, 49152
    s_mov_b32 s80, 0
    buffer_load_dwordx4 v3, s[52:55], s80 offen sc1 lds
    s_add_u32 m0, s89, 50176
    s_mov_b32 s80, 7168
    buffer_load_dwordx4 v4, s[52:55], s80 offen sc1 lds
    s_add_u32 m0, s89, 51200
    s_mov_b32 s80, 14336
    buffer_load_dwordx4 v3, s[52:55], s80 offen sc1 lds
    s_add_u32 m0, s89, 52224
    s_mov_b32 s80, 21504
    buffer_load_dwordx4 v4, s[52:55], s80 offen sc1 lds
    s_add_u32 m0, s89, 65536
    s_mov_b32 s80, 128
    buffer_load_dwordx4 v3, s[52:55], s80 offen sc1 lds
    s_add_u32 m0, s89, 66560
    s_mov_b32 s80, 7296
    buffer_load_dwordx4 v4, s[52:55], s80 offen sc1 lds
    s_add_u32 m0, s89, 67584
    s_mov_b32 s80, 14464
    buffer_load_dwordx4 v3, s[52:55], s80 offen sc1 lds
    s_add_u32 m0, s89, 68608
    s_mov_b32 s80, 21632
    buffer_load_dwordx4 v4, s[52:55], s80 offen sc1 lds
    s_add_u32 m0, s89, 81920
    s_mov_b32 s80, 256
    buffer_load_dwordx4 v3, s[52:55], s80 offen sc1 lds
    s_add_u32 m0, s89, 82944
    s_mov_b32 s80, 7424
    buffer_load_dwordx4 v4, s[52:55], s80 offen sc1 lds
    s_add_u32 m0, s89, 83968
    s_mov_b32 s80, 14592
    buffer_load_dwordx4 v3, s[52:55], s80 offen sc1 lds
    s_add_u32 m0, s89, 84992
    s_mov_b32 s80, 21760
    buffer_load_dwordx4 v4, s[52:55], s80 offen sc1 lds
    v_mov_b32 v12, 152264
    ds_read_b64 v[14:15], v12
    s_waitcnt lgkmcnt(0)
    v_readfirstlane_b32 s12, v14
    v_readfirstlane_b32 s13, v15
    v_lshrrev_b32 v12, 4, v1
    v_and_b32 v13, 15, v1
    v_lshrrev_b32 v14, 2, v13
    v_and_b32 v13, 3, v13
    v_lshrrev_b32 v15, 1, v12
    v_and_b32 v12, 1, v12
    v_lshl_add_u32 v15, v15, 3, v14
    v_lshlrev_b32 v15, 7, v15
    v_lshl_add_u32 v15, v13, 3, v15
    v_lshl_add_u32 v15, v12, 5, v15
    v_lshrrev_b32 v14, 1, v14
    s_and_b32 s80, s3, 1
    v_xor_b32 v14, s80, v14
    v_lshl_add_u32 v5, v14, 6, v15
    v_add_u32 v5, 0, v5
    v_and_b32 v12, 31, v1
    v_lshrrev_b32 v13, 5, v1
    v_bfe_u32 v14, v1, 1, 3
    v_xor_b32 v13, v13, v14
    v_lshlrev_b32 v12, 7, v12
    s_lshr_b32 s80, s3, 1
    s_lshl_b32 s80, s80, 13
    s_add_u32 s80, s80, 49152
    v_add_u32 v12, s80, v12
    v_xor_b32 v14, 0, v13
    v_lshl_add_u32 v6, v14, 4, v12
    v_xor_b32 v14, 2, v13
    v_lshl_add_u32 v7, v14, 4, v12
    v_xor_b32 v14, 4, v13
    v_lshl_add_u32 v8, v14, 4, v12
    v_xor_b32 v14, 6, v13
    v_lshl_add_u32 v9, v14, 4, v12
    v_accvgpr_write_b32 a0, 0
    v_accvgpr_write_b32 a1, 0
    v_accvgpr_write_b32 a2, 0
    v_accvgpr_write_b32 a3, 0
    v_accvgpr_write_b32 a4, 0
    v_accvgpr_write_b32 a5, 0
    v_accvgpr_write_b32 a6, 0
    v_accvgpr_write_b32 a7, 0
    v_accvgpr_write_b32 a8, 0
    v_accvgpr_write_b32 a9, 0
    v_accvgpr_write_b32 a10, 0
    v_accvgpr_write_b32 a11, 0
    v_accvgpr_write_b32 a12, 0
    v_accvgpr_write_b32 a13, 0
    v_accvgpr_write_b32 a14, 0
    v_accvgpr_write_b32 a15, 0
    v_accvgpr_write_b32 a16, 0
    v_accvgpr_write_b32 a17, 0
    v_accvgpr_write_b32 a18, 0
    v_accvgpr_write_b32 a19, 0
    v_accvgpr_write_b32 a20, 0
    v_accvgpr_write_b32 a21, 0
    v_accvgpr_write_b32 a22, 0
    v_accvgpr_write_b32 a23, 0
    v_accvgpr_write_b32 a24, 0
    v_accvgpr_write_b32 a25, 0
    v_accvgpr_write_b32 a26, 0
    v_accvgpr_write_b32 a27, 0
    v_accvgpr_write_b32 a28, 0
    v_accvgpr_write_b32 a29, 0
    v_accvgpr_write_b32 a30, 0
    v_accvgpr_write_b32 a31, 0
    v_accvgpr_write_b32 a32, 0
    v_accvgpr_write_b32 a33, 0
    v_accvgpr_write_b32 a34, 0
    v_accvgpr_write_b32 a35, 0
    v_accvgpr_write_b32 a36, 0
    v_accvgpr_write_b32 a37, 0
    v_accvgpr_write_b32 a38, 0
    v_accvgpr_write_b32 a39, 0
    v_accvgpr_write_b32 a40, 0
    v_accvgpr_write_b32 a41, 0
    v_accvgpr_write_b32 a42, 0
    v_accvgpr_write_b32 a43, 0
    v_accvgpr_write_b32 a44, 0
    v_accvgpr_write_b32 a45, 0
    v_accvgpr_write_b32 a46, 0
    v_accvgpr_write_b32 a47, 0
    v_accvgpr_write_b32 a48, 0
    v_accvgpr_write_b32 a49, 0
    v_accvgpr_write_b32 a50, 0
    v_accvgpr_write_b32 a51, 0
    v_accvgpr_write_b32 a52, 0
    v_accvgpr_write_b32 a53, 0
    v_accvgpr_write_b32 a54, 0
    v_accvgpr_write_b32 a55, 0
    v_accvgpr_write_b32 a56, 0
    v_accvgpr_write_b32 a57, 0
    v_accvgpr_write_b32 a58, 0
    v_accvgpr_write_b32 a59, 0
    v_accvgpr_write_b32 a60, 0
    v_accvgpr_write_b32 a61, 0
    v_accvgpr_write_b32 a62, 0
    v_accvgpr_write_b32 a63, 0
    v_accvgpr_write_b32 a64, 0
    v_accvgpr_write_b32 a65, 0
    v_accvgpr_write_b32 a66, 0
    v_accvgpr_write_b32 a67, 0
    v_accvgpr_write_b32 a68, 0
    v_accvgpr_write_b32 a69, 0
    v_accvgpr_write_b32 a70, 0
    v_accvgpr_write_b32 a71, 0
    v_accvgpr_write_b32 a72, 0
    v_accvgpr_write_b32 a73, 0
    v_accvgpr_write_b32 a74, 0
    v_accvgpr_write_b32 a75, 0
    v_accvgpr_write_b32 a76, 0
    v_accvgpr_write_b32 a77, 0
    v_accvgpr_write_b32 a78, 0
    v_accvgpr_write_b32 a79, 0
    v_accvgpr_write_b32 a80, 0
    v_accvgpr_write_b32 a81, 0
    v_accvgpr_write_b32 a82, 0
    v_accvgpr_write_b32 a83, 0
    v_accvgpr_write_b32 a84, 0
    v_accvgpr_write_b32 a85, 0
    v_accvgpr_write_b32 a86, 0
    v_accvgpr_write_b32 a87, 0
    v_accvgpr_write_b32 a88, 0
    v_accvgpr_write_b32 a89, 0
    v_accvgpr_write_b32 a90, 0
    v_accvgpr_write_b32 a91, 0
    v_accvgpr_write_b32 a92, 0
    v_accvgpr_write_b32 a93, 0
    v_accvgpr_write_b32 a94, 0
    v_accvgpr_write_b32 a95, 0
    v_accvgpr_write_b32 a96, 0
    v_accvgpr_write_b32 a97, 0
    v_accvgpr_write_b32 a98, 0
    v_accvgpr_write_b32 a99, 0
    v_accvgpr_write_b32 a100, 0
    v_accvgpr_write_b32 a101, 0
    v_accvgpr_write_b32 a102, 0
    v_accvgpr_write_b32 a103, 0
    v_accvgpr_write_b32 a104, 0
    v_accvgpr_write_b32 a105, 0
    v_accvgpr_write_b32 a106, 0
    v_accvgpr_write_b32 a107, 0
    v_accvgpr_write_b32 a108, 0
    v_accvgpr_write_b32 a109, 0
    v_accvgpr_write_b32 a110, 0
    v_accvgpr_write_b32 a111, 0
    v_accvgpr_write_b32 a112, 0
    v_accvgpr_write_b32 a113, 0
    v_accvgpr_write_b32 a114, 0
    v_accvgpr_write_b32 a115, 0
    v_accvgpr_write_b32 a116, 0
    v_accvgpr_write_b32 a117, 0
    v_accvgpr_write_b32 a118, 0
    v_accvgpr_write_b32 a119, 0
    v_accvgpr_write_b32 a120, 0
    v_accvgpr_write_b32 a121, 0
    v_accvgpr_write_b32 a122, 0
    v_accvgpr_write_b32 a123, 0
    v_accvgpr_write_b32 a124, 0
    v_accvgpr_write_b32 a125, 0
    v_accvgpr_write_b32 a126, 0
    v_accvgpr_write_b32 a127, 0
    s_add_u32 s72, s46, 4194304
    s_addc_u32 s73, s47, 0
    s_mov_b32 s74, 7340032
    s_mov_b32 s75, 0x00020000
    s_mul_i32 s90, s3, 2560
    s_add_u32 s90, s90, 152320
    v_and_b32 v12, 31, v1
    v_mul_u32_u24 v12, 80, v12
    v_lshrrev_b32 v13, 5, v1
    v_lshl_add_u32 v12, v13, 3, v12
    v_add_u32 v10, s90, v12
    v_lshrrev_b32 v12, 2, v1
    v_mul_u32_u24 v12, 80, v12
    v_and_b32 v13, 3, v1
    v_lshl_add_u32 v12, v13, 4, v12
    v_add_u32 v11, s90, v12
    s_mul_i32 s80, s85, 14
    s_add_u32 s80, s80, s86
    s_lshl_b32 s80, s80, 15
    s_and_b32 s81, s3, 1
    s_lshl_b32 s81, s81, 13
    s_add_u32 s80, s80, s81
    s_lshr_b32 s81, s3, 1
    s_lshl_b32 s81, s81, 12
    s_add_u32 s80, s80, s81
    v_lshlrev_b32 v12, 4, v1
    v_add_u32 v48, s80, v12
    s_waitcnt vmcnt(8)
    v_mov_b32 v14, 152192
    v_mov_b32 v15, 1
    s_mov_b64 exec, 1
    ds_add_u32 v14, v15
    s_mov_b64 exec, -1
GB_28:
    ds_read_b32 v15, v14
    s_waitcnt lgkmcnt(0)
    v_readfirstlane_b32 s84, v15
    s_nop 0
    s_cmp_ge_u32 s84, 12
    s_cbranch_scc0 GB_28
    ds_read_b64_tr_b16 v[16:17], v5 offset:0
    ds_read_b64_tr_b16 v[18:19], v5 offset:512
    ds_read_b64_tr_b16 v[20:21], v5 offset:8192
    ds_read_b64_tr_b16 v[22:23], v5 offset:8704
    ds_read_b128 v[24:27], v6 offset:0
    ds_read_b128 v[28:31], v6 offset:4096
    s_waitcnt lgkmcnt(0)
    v_mfma_f32_32x32x16_bf16 a[0:15], v[16:19], v[24:27], a[0:15]
    ds_read_b64_tr_b16 v[32:33], v5 offset:2048
    ds_read_b64_tr_b16 v[34:35], v5 offset:2560
    v_mfma_f32_32x32x16_bf16 a[16:31], v[16:19], v[28:31], a[16:31]
    ds_read_b64_tr_b16 v[36:37], v5 offset:10240
    v_mfma_f32_32x32x16_bf16 a[32:47], v[20:23], v[24:27], a[32:47]
    ds_read_b64_tr_b16 v[38:39], v5 offset:10752
    ds_read_b128 v[40:43], v7 offset:0
    v_mfma_f32_32x32x16_bf16 a[48:63], v[20:23], v[28:31], a[48:63]
    ds_read_b128 v[44:47], v7 offset:4096
    s_waitcnt lgkmcnt(0)
    v_mfma_f32_32x32x16_bf16 a[0:15], v[32:35], v[40:43], a[0:15]
    ds_read_b64_tr_b16 v[16:17], v5 offset:4096
    ds_read_b64_tr_b16 v[18:19], v5 offset:4608
    v_mfma_f32_32x32x16_bf16 a[16:31], v[32:35], v[44:47], a[16:31]
    ds_read_b64_tr_b16 v[20:21], v5 offset:12288
    v_mfma_f32_32x32x16_bf16 a[32:47], v[36:39], v[40:43], a[32:47]
    ds_read_b64_tr_b16 v[22:23], v5 offset:12800
    ds_read_b128 v[24:27], v8 offset:0
    v_mfma_f32_32x32x16_bf16 a[48:63], v[36:39], v[44:47], a[48:63]
    ds_read_b128 v[28:31], v8 offset:4096
    s_waitcnt lgkmcnt(0)
    v_mfma_f32_32x32x16_bf16 a[0:15], v[16:19], v[24:27], a[0:15]
    ds_read_b64_tr_b16 v[32:33], v5 offset:6144
    ds_read_b64_tr_b16 v[34:35], v5 offset:6656
    v_mfma_f32_32x32x16_bf16 a[16:31], v[16:19], v[28:31], a[16:31]
    ds_read_b64_tr_b16 v[36:37], v5 offset:14336
    v_mfma_f32_32x32x16_bf16 a[32:47], v[20:23], v[24:27], a[32:47]
    ds_read_b64_tr_b16 v[38:39], v5 offset:14848
    ds_read_b128 v[40:43], v9 offset:0
    v_mfma_f32_32x32x16_bf16 a[48:63], v[20:23], v[28:31], a[48:63]
    ds_read_b128 v[44:47], v9 offset:4096
    s_waitcnt lgkmcnt(0)
    s_waitcnt vmcnt(4)
    v_mov_b32 v14, 152192
    v_mov_b32 v15, 1
    s_mov_b64 exec, 1
    ds_add_u32 v14, v15
    s_mov_b64 exec, -1
    v_mfma_f32_32x32x16_bf16 a[0:15], v[32:35], v[40:43], a[0:15]
    v_mfma_f32_32x32x16_bf16 a[16:31], v[32:35], v[44:47], a[16:31]
GB_29:
    ds_read_b32 v15, v14
    s_waitcnt lgkmcnt(0)
    v_readfirstlane_b32 s84, v15
    s_nop 0
    s_cmp_ge_u32 s84, 16
    s_cbranch_scc0 GB_29
    v_mfma_f32_32x32x16_bf16 a[32:47], v[36:39], v[40:43], a[32:47]
    ds_read_b64_tr_b16 v[16:17], v5 offset:16384
    ds_read_b64_tr_b16 v[18:19], v5 offset:16896
    ds_read_b64_tr_b16 v[20:21], v5 offset:24576
    v_mfma_f32_32x32x16_bf16 a[48:63], v[36:39], v[44:47], a[48:63]
    ds_read_b64_tr_b16 v[22:23], v5 offset:25088
    ds_read_b128 v[24:27], v6 offset:16384
    ds_read_b128 v[28:31], v6 offset:20480
    s_waitcnt lgkmcnt(0)
    v_mfma_f32_32x32x16_bf16 a[0:15], v[16:19], v[24:27], a[0:15]
    ds_read_b64_tr_b16 v[32:33], v5 offset:18432
    ds_read_b64_tr_b16 v[34:35], v5 offset:18944
    ds_read_b64_tr_b16 v[36:37], v5 offset:26624
    v_mfma_f32_32x32x16_bf16 a[16:31], v[16:19], v[28:31], a[16:31]
    ds_read_b64_tr_b16 v[38:39], v5 offset:27136
    ds_read_b128 v[40:43], v7 offset:16384
    v_mfma_f32_32x32x16_bf16 a[32:47], v[20:23], v[24:27], a[32:47]
    ds_read_b128 v[44:47], v7 offset:20480
    s_add_u32 m0, s89, 0
    s_mov_b32 s80, 688128
    buffer_load_dwordx4 v2, s[64:67], s80 offen lds
    v_mfma_f32_32x32x16_bf16 a[48:63], v[20:23], v[28:31], a[48:63]
    s_add_u32 m0, s89, 1024
    s_mov_b32 s80, 716800
    buffer_load_dwordx4 v2, s[64:67], s80 offen lds
    s_add_u32 m0, s89, 2048
    s_mov_b32 s80, 745472
    buffer_load_dwordx4 v2, s[64:67], s80 offen lds
    s_waitcnt lgkmcnt(0)
    v_mfma_f32_32x32x16_bf16 a[0:15], v[32:35], v[40:43], a[0:15]
    ds_read_b64_tr_b16 v[16:17], v5 offset:20480
    ds_read_b64_tr_b16 v[18:19], v5 offset:20992
    ds_read_b64_tr_b16 v[20:21], v5 offset:28672
    v_mfma_f32_32x32x16_bf16 a[16:31], v[32:35], v[44:47], a[16:31]
    ds_read_b64_tr_b16 v[22:23], v5 offset:29184
    ds_read_b128 v[24:27], v8 offset:16384
    v_mfma_f32_32x32x16_bf16 a[32:47], v[36:39], v[40:43], a[32:47]
    ds_read_b128 v[28:31], v8 offset:20480
    s_add_u32 m0, s89, 3072
    s_mov_b32 s80, 774144
    buffer_load_dwordx4 v2, s[64:67], s80 offen lds
    v_mfma_f32_32x32x16_bf16 a[48:63], v[36:39], v[44:47], a[48:63]
    s_add_u32 m0, s89, 49152
    s_mov_b32 s80, 384
    buffer_load_dwordx4 v3, s[52:55], s80 offen sc1 lds
    s_add_u32 m0, s89, 50176
    s_mov_b32 s80, 7552
    buffer_load_dwordx4 v4, s[52:55], s80 offen sc1 lds
    s_waitcnt lgkmcnt(0)
    v_mfma_f32_32x32x16_bf16 a[0:15], v[16:19], v[24:27], a[0:15]
    ds_read_b64_tr_b16 v[32:33], v5 offset:22528
    ds_read_b64_tr_b16 v[34:35], v5 offset:23040
    v_mfma_f32_32x32x16_bf16 a[16:31], v[16:19], v[28:31], a[16:31]
    ds_read_b64_tr_b16 v[36:37], v5 offset:30720
    ds_read_b64_tr_b16 v[38:39], v5 offset:31232
    v_mfma_f32_32x32x16_bf16 a[32:47], v[20:23], v[24:27], a[32:47]
    ds_read_b128 v[40:43], v9 offset:16384
    ds_read_b128 v[44:47], v9 offset:20480
    v_mfma_f32_32x32x16_bf16 a[48:63], v[20:23], v[28:31], a[48:63]
    s_add_u32 m0, s89, 51200
    s_mov_b32 s80, 14720
    buffer_load_dwordx4 v3, s[52:55], s80 offen sc1 lds
    s_add_u32 m0, s89, 52224
    s_mov_b32 s80, 21888
    buffer_load_dwordx4 v4, s[52:55], s80 offen sc1 lds
    s_waitcnt lgkmcnt(0)
    s_waitcnt vmcnt(8)
    v_mov_b32 v14, 152192
    v_mov_b32 v15, 1
    s_mov_b64 exec, 1
    ds_add_u32 v14, v15
    s_mov_b64 exec, -1
    v_mfma_f32_32x32x16_bf16 a[0:15], v[32:35], v[40:43], a[0:15]
    v_mfma_f32_32x32x16_bf16 a[16:31], v[32:35], v[44:47], a[16:31]
GB_30:
    ds_read_b32 v15, v14
    s_waitcnt lgkmcnt(0)
    v_readfirstlane_b32 s84, v15
    s_nop 0
    s_cmp_ge_u32 s84, 20
    s_cbranch_scc0 GB_30
    v_mfma_f32_32x32x16_bf16 a[32:47], v[36:39], v[40:43], a[32:47]
    ds_read_b64_tr_b16 v[16:17], v5 offset:32768
    ds_read_b64_tr_b16 v[18:19], v5 offset:33280
    ds_read_b64_tr_b16 v[20:21], v5 offset:40960
    v_mfma_f32_32x32x16_bf16 a[48:63], v[36:39], v[44:47], a[48:63]
    ds_read_b64_tr_b16 v[22:23], v5 offset:41472
    ds_read_b128 v[24:27], v6 offset:32768
    ds_read_b128 v[28:31], v6 offset:36864
    s_waitcnt lgkmcnt(0)
    v_mfma_f32_32x32x16_bf16 a[0:15], v[16:19], v[24:27], a[0:15]
    ds_read_b64_tr_b16 v[32:33], v5 offset:34816
    ds_read_b64_tr_b16 v[34:35], v5 offset:35328
    ds_read_b64_tr_b16 v[36:37], v5 offset:43008
    v_mfma_f32_32x32x16_bf16 a[16:31], v[16:19], v[28:31], a[16:31]
    ds_read_b64_tr_b16 v[38:39], v5 offset:43520
    ds_read_b128 v[40:43], v7 offset:32768
    v_mfma_f32_32x32x16_bf16 a[32:47], v[20:23], v[24:27], a[32:47]
    ds_read_b128 v[44:47], v7 offset:36864
    s_add_u32 m0, s89, 16384
    s_mov_b32 s80, 917504
    buffer_load_dwordx4 v2, s[64:67], s80 offen lds
    v_mfma_f32_32x32x16_bf16 a[48:63], v[20:23], v[28:31], a[48:63]
    s_add_u32 m0, s89, 17408
    s_mov_b32 s80, 946176
    buffer_load_dwordx4 v2, s[64:67], s80 offen lds
    s_add_u32 m0, s89, 18432
    s_mov_b32 s80, 974848
    buffer_load_dwordx4 v2, s[64:67], s80 offen lds
    s_waitcnt lgkmcnt(0)
    v_mfma_f32_32x32x16_bf16 a[0:15], v[32:35], v[40:43], a[0:15]
    ds_read_b64_tr_b16 v[16:17], v5 offset:36864
    ds_read_b64_tr_b16 v[18:19], v5 offset:37376
    ds_read_b64_tr_b16 v[20:21], v5 offset:45056
    v_mfma_f32_32x32x16_bf16 a[16:31], v[32:35], v[44:47], a[16:31]
    ds_read_b64_tr_b16 v[22:23], v5 offset:45568
    ds_read_b128 v[24:27], v8 offset:32768
    v_mfma_f32_32x32x16_bf16 a[32:47], v[36:39], v[40:43], a[32:47]
    ds_read_b128 v[28:31], v8 offset:36864
    s_add_u32 m0, s89, 19456
    s_mov_b32 s80, 1003520
    buffer_load_dwordx4 v2, s[64:67], s80 offen lds
    v_mfma_f32_32x32x16_bf16 a[48:63], v[36:39], v[44:47], a[48:63]
    s_add_u32 m0, s89, 65536
    s_mov_b32 s80, 512
    buffer_load_dwordx4 v3, s[52:55], s80 offen sc1 lds
    s_add_u32 m0, s89, 66560
    s_mov_b32 s80, 7680
    buffer_load_dwordx4 v4, s[52:55], s80 offen sc1 lds
    s_waitcnt lgkmcnt(0)
    v_mfma_f32_32x32x16_bf16 a[0:15], v[16:19], v[24:27], a[0:15]
    ds_read_b64_tr_b16 v[32:33], v5 offset:38912
    ds_read_b64_tr_b16 v[34:35], v5 offset:39424
    v_mfma_f32_32x32x16_bf16 a[16:31], v[16:19], v[28:31], a[16:31]
    ds_read_b64_tr_b16 v[36:37], v5 offset:47104
    ds_read_b64_tr_b16 v[38:39], v5 offset:47616
    v_mfma_f32_32x32x16_bf16 a[32:47], v[20:23], v[24:27], a[32:47]
    ds_read_b128 v[40:43], v9 offset:32768
    ds_read_b128 v[44:47], v9 offset:36864
    v_mfma_f32_32x32x16_bf16 a[48:63], v[20:23], v[28:31], a[48:63]
    s_add_u32 m0, s89, 67584
    s_mov_b32 s80, 14848
    buffer_load_dwordx4 v3, s[52:55], s80 offen sc1 lds
    s_add_u32 m0, s89, 68608
    s_mov_b32 s80, 22016
    buffer_load_dwordx4 v4, s[52:55], s80 offen sc1 lds
    s_waitcnt lgkmcnt(0)
    s_waitcnt vmcnt(8)
    v_mov_b32 v14, 152192
    v_mov_b32 v15, 1
    s_mov_b64 exec, 1
    ds_add_u32 v14, v15
    s_mov_b64 exec, -1
    v_mfma_f32_32x32x16_bf16 a[0:15], v[32:35], v[40:43], a[0:15]
    v_mfma_f32_32x32x16_bf16 a[16:31], v[32:35], v[44:47], a[16:31]
GB_31:
    ds_read_b32 v15, v14
    s_waitcnt lgkmcnt(0)
    v_readfirstlane_b32 s84, v15
    s_nop 0
    s_cmp_ge_u32 s84, 24
    s_cbranch_scc0 GB_31
    v_mfma_f32_32x32x16_bf16 a[32:47], v[36:39], v[40:43], a[32:47]
    ds_read_b64_tr_b16 v[16:17], v5 offset:0
    ds_read_b64_tr_b16 v[18:19], v5 offset:512
    ds_read_b64_tr_b16 v[20:21], v5 offset:8192
    v_mfma_f32_32x32x16_bf16 a[48:63], v[36:39], v[44:47], a[48:63]
    ds_read_b64_tr_b16 v[22:23], v5 offset:8704
    ds_read_b128 v[24:27], v6 offset:0
    ds_read_b128 v[28:31], v6 offset:4096
    s_waitcnt lgkmcnt(0)
    v_mfma_f32_32x32x16_bf16 a[0:15], v[16:19], v[24:27], a[0:15]
    ds_read_b64_tr_b16 v[32:33], v5 offset:2048
    ds_read_b64_tr_b16 v[34:35], v5 offset:2560
    ds_read_b64_tr_b16 v[36:37], v5 offset:10240
    v_mfma_f32_32x32x16_bf16 a[16:31], v[16:19], v[28:31], a[16:31]
    ds_read_b64_tr_b16 v[38:39], v5 offset:10752
    ds_read_b128 v[40:43], v7 offset:0
    v_mfma_f32_32x32x16_bf16 a[32:47], v[20:23], v[24:27], a[32:47]
    ds_read_b128 v[44:47], v7 offset:4096
    s_add_u32 m0, s89, 32768
    s_mov_b32 s80, 1146880
    buffer_load_dwordx4 v2, s[64:67], s80 offen lds
    v_mfma_f32_32x32x16_bf16 a[48:63], v[20:23], v[28:31], a[48:63]
    s_add_u32 m0, s89, 33792
    s_mov_b32 s80, 1175552
    buffer_load_dwordx4 v2, s[64:67], s80 offen lds
    s_add_u32 m0, s89, 34816
    s_mov_b32 s80, 1204224
    buffer_load_dwordx4 v2, s[64:67], s80 offen lds
    s_waitcnt lgkmcnt(0)
    v_mfma_f32_32x32x16_bf16 a[0:15], v[32:35], v[40:43], a[0:15]
    ds_read_b64_tr_b16 v[16:17], v5 offset:4096
    ds_read_b64_tr_b16 v[18:19], v5 offset:4608
    ds_read_b64_tr_b16 v[20:21], v5 offset:12288
    v_mfma_f32_32x32x16_bf16 a[16:31], v[32:35], v[44:47], a[16:31]
    ds_read_b64_tr_b16 v[22:23], v5 offset:12800
    ds_read_b128 v[24:27], v8 offset:0
    v_mfma_f32_32x32x16_bf16 a[32:47], v[36:39], v[40:43], a[32:47]
    ds_read_b128 v[28:31], v8 offset:4096
    s_add_u32 m0, s89, 35840
    s_mov_b32 s80, 1232896
    buffer_load_dwordx4 v2, s[64:67], s80 offen lds
    v_mfma_f32_32x32x16_bf16 a[48:63], v[36:39], v[44:47], a[48:63]
    s_add_u32 m0, s89, 81920
    s_mov_b32 s80, 640
    buffer_load_dwordx4 v3, s[52:55], s80 offen sc1 lds
    s_add_u32 m0, s89, 82944
    s_mov_b32 s80, 7808
    buffer_load_dwordx4 v4, s[52:55], s80 offen sc1 lds
    s_waitcnt lgkmcnt(0)
    v_mfma_f32_32x32x16_bf16 a[0:15], v[16:19], v[24:27], a[0:15]
    ds_read_b64_tr_b16 v[32:33], v5 offset:6144
    ds_read_b64_tr_b16 v[34:35], v5 offset:6656
    v_mfma_f32_32x32x16_bf16 a[16:31], v[16:19], v[28:31], a[16:31]
    ds_read_b64_tr_b16 v[36:37], v5 offset:14336
    ds_read_b64_tr_b16 v[38:39], v5 offset:14848
    v_mfma_f32_32x32x16_bf16 a[32:47], v[20:23], v[24:27], a[32:47]
    ds_read_b128 v[40:43], v9 offset:0
    ds_read_b128 v[44:47], v9 offset:4096
    v_mfma_f32_32x32x16_bf16 a[48:63], v[20:23], v[28:31], a[48:63]
    s_add_u32 m0, s89, 83968
    s_mov_b32 s80, 14976
    buffer_load_dwordx4 v3, s[52:55], s80 offen sc1 lds
    s_add_u32 m0, s89, 84992
    s_mov_b32 s80, 22144
    buffer_load_dwordx4 v4, s[52:55], s80 offen sc1 lds
    s_waitcnt lgkmcnt(0)
    s_waitcnt vmcnt(8)
    v_mov_b32 v14, 152192
    v_mov_b32 v15, 1
    s_mov_b64 exec, 1
    ds_add_u32 v14, v15
    s_mov_b64 exec, -1
    v_mfma_f32_32x32x16_bf16 a[0:15], v[32:35], v[40:43], a[0:15]
    v_mfma_f32_32x32x16_bf16 a[16:31], v[32:35], v[44:47], a[16:31]
GB_32:
    ds_read_b32 v15, v14
    s_waitcnt lgkmcnt(0)
    v_readfirstlane_b32 s84, v15
    s_nop 0
    s_cmp_ge_u32 s84, 28
    s_cbranch_scc0 GB_32
    v_mfma_f32_32x32x16_bf16 a[32:47], v[36:39], v[40:43], a[32:47]
    ds_read_b64_tr_b16 v[16:17], v5 offset:16384
    ds_read_b64_tr_b16 v[18:19], v5 offset:16896
    ds_read_b64_tr_b16 v[20:21], v5 offset:24576
    v_mfma_f32_32x32x16_bf16 a[48:63], v[36:39], v[44:47], a[48:63]
    ds_read_b64_tr_b16 v[22:23], v5 offset:25088
    ds_read_b128 v[24:27], v6 offset:16384
    ds_read_b128 v[28:31], v6 offset:20480
    s_waitcnt lgkmcnt(0)
    v_mfma_f32_32x32x16_bf16 a[0:15], v[16:19], v[24:27], a[0:15]
    ds_read_b64_tr_b16 v[32:33], v5 offset:18432
    ds_read_b64_tr_b16 v[34:35], v5 offset:18944
    ds_read_b64_tr_b16 v[36:37], v5 offset:26624
    v_mfma_f32_32x32x16_bf16 a[16:31], v[16:19], v[28:31], a[16:31]
    ds_read_b64_tr_b16 v[38:39], v5 offset:27136
    ds_read_b128 v[40:43], v7 offset:16384
    v_mfma_f32_32x32x16_bf16 a[32:47], v[20:23], v[24:27], a[32:47]
    ds_read_b128 v[44:47], v7 offset:20480
    s_add_u32 m0, s89, 0
    s_mov_b32 s80, 1376256
    buffer_load_dwordx4 v2, s[64:67], s80 offen lds
    v_mfma_f32_32x32x16_bf16 a[48:63], v[20:23], v[28:31], a[48:63]
    s_add_u32 m0, s89, 1024
    s_mov_b32 s80, 1404928
    buffer_load_dwordx4 v2, s[64:67], s80 offen lds
    s_add_u32 m0, s89, 2048
    s_mov_b32 s80, 1433600
    buffer_load_dwordx4 v2, s[64:67], s80 offen lds
    s_waitcnt lgkmcnt(0)
    v_mfma_f32_32x32x16_bf16 a[0:15], v[32:35], v[40:43], a[0:15]
    ds_read_b64_tr_b16 v[16:17], v5 offset:20480
    ds_read_b64_tr_b16 v[18:19], v5 offset:20992
    ds_read_b64_tr_b16 v[20:21], v5 offset:28672
    v_mfma_f32_32x32x16_bf16 a[16:31], v[32:35], v[44:47], a[16:31]
    ds_read_b64_tr_b16 v[22:23], v5 offset:29184
    ds_read_b128 v[24:27], v8 offset:16384
    v_mfma_f32_32x32x16_bf16 a[32:47], v[36:39], v[40:43], a[32:47]
    ds_read_b128 v[28:31], v8 offset:20480
    s_add_u32 m0, s89, 3072
    s_mov_b32 s80, 1462272
    buffer_load_dwordx4 v2, s[64:67], s80 offen lds
    v_mfma_f32_32x32x16_bf16 a[48:63], v[36:39], v[44:47], a[48:63]
    s_add_u32 m0, s89, 49152
    s_mov_b32 s80, 768
    buffer_load_dwordx4 v3, s[52:55], s80 offen sc1 lds
    s_add_u32 m0, s89, 50176
    s_mov_b32 s80, 7936
    buffer_load_dwordx4 v4, s[52:55], s80 offen sc1 lds
    s_waitcnt lgkmcnt(0)
    v_mfma_f32_32x32x16_bf16 a[0:15], v[16:19], v[24:27], a[0:15]
    ds_read_b64_tr_b16 v[32:33], v5 offset:22528
    ds_read_b64_tr_b16 v[34:35], v5 offset:23040
    v_mfma_f32_32x32x16_bf16 a[16:31], v[16:19], v[28:31], a[16:31]
    ds_read_b64_tr_b16 v[36:37], v5 offset:30720
    ds_read_b64_tr_b16 v[38:39], v5 offset:31232
    v_mfma_f32_32x32x16_bf16 a[32:47], v[20:23], v[24:27], a[32:47]
    ds_read_b128 v[40:43], v9 offset:16384
    ds_read_b128 v[44:47], v9 offset:20480
    v_mfma_f32_32x32x16_bf16 a[48:63], v[20:23], v[28:31], a[48:63]
    s_add_u32 m0, s89, 51200
    s_mov_b32 s80, 15104
    buffer_load_dwordx4 v3, s[52:55], s80 offen sc1 lds
    s_add_u32 m0, s89, 52224
    s_mov_b32 s80, 22272
    buffer_load_dwordx4 v4, s[52:55], s80 offen sc1 lds
    s_waitcnt lgkmcnt(0)
    s_waitcnt vmcnt(8)
    v_mov_b32 v14, 152192
    v_mov_b32 v15, 1
    s_mov_b64 exec, 1
    ds_add_u32 v14, v15
    s_mov_b64 exec, -1
    v_mfma_f32_32x32x16_bf16 a[0:15], v[32:35], v[40:43], a[0:15]
    v_mfma_f32_32x32x16_bf16 a[16:31], v[32:35], v[44:47], a[16:31]
GB_33:
    ds_read_b32 v15, v14
    s_waitcnt lgkmcnt(0)
    v_readfirstlane_b32 s84, v15
    s_nop 0
    s_cmp_ge_u32 s84, 32
    s_cbranch_scc0 GB_33
    v_mfma_f32_32x32x16_bf16 a[32:47], v[36:39], v[40:43], a[32:47]
    ds_read_b64_tr_b16 v[16:17], v5 offset:32768
    ds_read_b64_tr_b16 v[18:19], v5 offset:33280
    ds_read_b64_tr_b16 v[20:21], v5 offset:40960
    v_mfma_f32_32x32x16_bf16 a[48:63], v[36:39], v[44:47], a[48:63]
    ds_read_b64_tr_b16 v[22:23], v5 offset:41472
    ds_read_b128 v[24:27], v6 offset:32768
    ds_read_b128 v[28:31], v6 offset:36864
    s_waitcnt lgkmcnt(0)
    v_mfma_f32_32x32x16_bf16 a[0:15], v[16:19], v[24:27], a[0:15]
    ds_read_b64_tr_b16 v[32:33], v5 offset:34816
    ds_read_b64_tr_b16 v[34:35], v5 offset:35328
    ds_read_b64_tr_b16 v[36:37], v5 offset:43008
    v_mfma_f32_32x32x16_bf16 a[16:31], v[16:19], v[28:31], a[16:31]
    ds_read_b64_tr_b16 v[38:39], v5 offset:43520
    ds_read_b128 v[40:43], v7 offset:32768
    v_mfma_f32_32x32x16_bf16 a[32:47], v[20:23], v[24:27], a[32:47]
    ds_read_b128 v[44:47], v7 offset:36864
    s_add_u32 m0, s89, 16384
    s_mov_b32 s80, 128
    buffer_load_dwordx4 v2, s[64:67], s80 offen lds
    v_mfma_f32_32x32x16_bf16 a[48:63], v[20:23], v[28:31], a[48:63]
    s_add_u32 m0, s89, 17408
    s_mov_b32 s80, 28800
    buffer_load_dwordx4 v2, s[64:67], s80 offen lds
    s_add_u32 m0, s89, 18432
    s_mov_b32 s80, 57472
    buffer_load_dwordx4 v2, s[64:67], s80 offen lds
    s_waitcnt lgkmcnt(0)
    v_mfma_f32_32x32x16_bf16 a[0:15], v[32:35], v[40:43], a[0:15]
    ds_read_b64_tr_b16 v[16:17], v5 offset:36864
    ds_read_b64_tr_b16 v[18:19], v5 offset:37376
    ds_read_b64_tr_b16 v[20:21], v5 offset:45056
    v_mfma_f32_32x32x16_bf16 a[16:31], v[32:35], v[44:47], a[16:31]
    ds_read_b64_tr_b16 v[22:23], v5 offset:45568
    ds_read_b128 v[24:27], v8 offset:32768
    v_mfma_f32_32x32x16_bf16 a[32:47], v[36:39], v[40:43], a[32:47]
    ds_read_b128 v[28:31], v8 offset:36864
    s_add_u32 m0, s89, 19456
    s_mov_b32 s80, 86144
    buffer_load_dwordx4 v2, s[64:67], s80 offen lds
    v_mfma_f32_32x32x16_bf16 a[48:63], v[36:39], v[44:47], a[48:63]
    s_add_u32 m0, s89, 65536
    s_mov_b32 s80, 0
    buffer_load_dwordx4 v3, s[52:55], s80 offen sc1 lds
    s_add_u32 m0, s89, 66560
    s_mov_b32 s80, 7168
    buffer_load_dwordx4 v4, s[52:55], s80 offen sc1 lds
    s_waitcnt lgkmcnt(0)
    v_mfma_f32_32x32x16_bf16 a[0:15], v[16:19], v[24:27], a[0:15]
    ds_read_b64_tr_b16 v[32:33], v5 offset:38912
    ds_read_b64_tr_b16 v[34:35], v5 offset:39424
    v_mfma_f32_32x32x16_bf16 a[16:31], v[16:19], v[28:31], a[16:31]
    ds_read_b64_tr_b16 v[36:37], v5 offset:47104
    ds_read_b64_tr_b16 v[38:39], v5 offset:47616
    v_mfma_f32_32x32x16_bf16 a[32:47], v[20:23], v[24:27], a[32:47]
    ds_read_b128 v[40:43], v9 offset:32768
    ds_read_b128 v[44:47], v9 offset:36864
    v_mfma_f32_32x32x16_bf16 a[48:63], v[20:23], v[28:31], a[48:63]
    s_add_u32 m0, s89, 67584
    s_mov_b32 s80, 14336
    buffer_load_dwordx4 v3, s[52:55], s80 offen sc1 lds
    s_add_u32 m0, s89, 68608
    s_mov_b32 s80, 21504
    buffer_load_dwordx4 v4, s[52:55], s80 offen sc1 lds
    s_waitcnt lgkmcnt(0)
    s_waitcnt vmcnt(8)
    v_mov_b32 v14, 152192
    v_mov_b32 v15, 1
    s_mov_b64 exec, 1
    ds_add_u32 v14, v15
    s_mov_b64 exec, -1
    v_mfma_f32_32x32x16_bf16 a[0:15], v[32:35], v[40:43], a[0:15]
    v_mfma_f32_32x32x16_bf16 a[16:31], v[32:35], v[44:47], a[16:31]
GB_34:
    ds_read_b32 v15, v14
    s_waitcnt lgkmcnt(0)
    v_readfirstlane_b32 s84, v15
    s_nop 0
    s_cmp_ge_u32 s84, 36
    s_cbranch_scc0 GB_34
    v_mfma_f32_32x32x16_bf16 a[32:47], v[36:39], v[40:43], a[32:47]
    ds_read_b64_tr_b16 v[16:17], v5 offset:0
    ds_read_b64_tr_b16 v[18:19], v5 offset:512
    ds_read_b64_tr_b16 v[20:21], v5 offset:8192
    v_mfma_f32_32x32x16_bf16 a[48:63], v[36:39], v[44:47], a[48:63]
    ds_read_b64_tr_b16 v[22:23], v5 offset:8704
    ds_read_b128 v[24:27], v6 offset:0
    ds_read_b128 v[28:31], v6 offset:4096
    s_waitcnt lgkmcnt(0)
    v_mfma_f32_32x32x16_bf16 a[0:15], v[16:19], v[24:27], a[0:15]
    ds_read_b64_tr_b16 v[32:33], v5 offset:2048
    ds_read_b64_tr_b16 v[34:35], v5 offset:2560
    ds_read_b64_tr_b16 v[36:37], v5 offset:10240
    v_mfma_f32_32x32x16_bf16 a[16:31], v[16:19], v[28:31], a[16:31]
    ds_read_b64_tr_b16 v[38:39], v5 offset:10752
    ds_read_b128 v[40:43], v7 offset:0
    v_mfma_f32_32x32x16_bf16 a[32:47], v[20:23], v[24:27], a[32:47]
    ds_read_b128 v[44:47], v7 offset:4096
    s_add_u32 m0, s89, 32768
    s_mov_b32 s80, 229504
    buffer_load_dwordx4 v2, s[64:67], s80 offen lds
    v_mfma_f32_32x32x16_bf16 a[48:63], v[20:23], v[28:31], a[48:63]
    s_add_u32 m0, s89, 33792
    s_mov_b32 s80, 258176
    buffer_load_dwordx4 v2, s[64:67], s80 offen lds
    s_add_u32 m0, s89, 34816
    s_mov_b32 s80, 286848
    buffer_load_dwordx4 v2, s[64:67], s80 offen lds
    s_waitcnt lgkmcnt(0)
    v_mfma_f32_32x32x16_bf16 a[0:15], v[32:35], v[40:43], a[0:15]
    ds_read_b64_tr_b16 v[16:17], v5 offset:4096
    ds_read_b64_tr_b16 v[18:19], v5 offset:4608
    ds_read_b64_tr_b16 v[20:21], v5 offset:12288
    v_mfma_f32_32x32x16_bf16 a[16:31], v[32:35], v[44:47], a[16:31]
    ds_read_b64_tr_b16 v[22:23], v5 offset:12800
    ds_read_b128 v[24:27], v8 offset:0
    v_mfma_f32_32x32x16_bf16 a[32:47], v[36:39], v[40:43], a[32:47]
    ds_read_b128 v[28:31], v8 offset:4096
    s_add_u32 m0, s89, 35840
    s_mov_b32 s80, 315520
    buffer_load_dwordx4 v2, s[64:67], s80 offen lds
    v_mfma_f32_32x32x16_bf16 a[48:63], v[36:39], v[44:47], a[48:63]
    s_add_u32 m0, s89, 81920
    s_mov_b32 s80, 128
    buffer_load_dwordx4 v3, s[52:55], s80 offen sc1 lds
    s_add_u32 m0, s89, 82944
    s_mov_b32 s80, 7296
    buffer_load_dwordx4 v4, s[52:55], s80 offen sc1 lds
    s_waitcnt lgkmcnt(0)
    v_mfma_f32_32x32x16_bf16 a[0:15], v[16:19], v[24:27], a[0:15]
    ds_read_b64_tr_b16 v[32:33], v5 offset:6144
    ds_read_b64_tr_b16 v[34:35], v5 offset:6656
    v_mfma_f32_32x32x16_bf16 a[16:31], v[16:19], v[28:31], a[16:31]
    ds_read_b64_tr_b16 v[36:37], v5 offset:14336
    ds_read_b64_tr_b16 v[38:39], v5 offset:14848
    v_mfma_f32_32x32x16_bf16 a[32:47], v[20:23], v[24:27], a[32:47]
    ds_read_b128 v[40:43], v9 offset:0
    ds_read_b128 v[44:47], v9 offset:4096
    v_mfma_f32_32x32x16_bf16 a[48:63], v[20:23], v[28:31], a[48:63]
    s_add_u32 m0, s89, 83968
    s_mov_b32 s80, 14464
    buffer_load_dwordx4 v3, s[52:55], s80 offen sc1 lds
    s_add_u32 m0, s89, 84992
    s_mov_b32 s80, 21632
    buffer_load_dwordx4 v4, s[52:55], s80 offen sc1 lds
    s_waitcnt lgkmcnt(0)
    s_waitcnt vmcnt(8)
    v_mov_b32 v14, 152192
    v_mov_b32 v15, 1
    s_mov_b64 exec, 1
    ds_add_u32 v14, v15
    s_mov_b64 exec, -1
    v_mfma_f32_32x32x16_bf16 a[0:15], v[32:35], v[40:43], a[0:15]
    v_mfma_f32_32x32x16_bf16 a[16:31], v[32:35], v[44:47], a[16:31]
GB_35:
    ds_read_b32 v15, v14
    s_waitcnt lgkmcnt(0)
    v_readfirstlane_b32 s84, v15
    s_nop 0
    s_cmp_ge_u32 s84, 40
    s_cbranch_scc0 GB_35
    v_mfma_f32_32x32x16_bf16 a[32:47], v[36:39], v[40:43], a[32:47]
    ds_read_b64_tr_b16 v[16:17], v5 offset:16384
    ds_read_b64_tr_b16 v[18:19], v5 offset:16896
    ds_read_b64_tr_b16 v[20:21], v5 offset:24576
    v_mfma_f32_32x32x16_bf16 a[48:63], v[36:39], v[44:47], a[48:63]
    ds_read_b64_tr_b16 v[22:23], v5 offset:25088
    ds_read_b128 v[24:27], v6 offset:16384
    ds_read_b128 v[28:31], v6 offset:20480
    s_waitcnt lgkmcnt(0)
    v_mfma_f32_32x32x16_bf16 a[64:79], v[16:19], v[24:27], a[64:79]
    ds_read_b64_tr_b16 v[32:33], v5 offset:18432
    ds_read_b64_tr_b16 v[34:35], v5 offset:18944
    ds_read_b64_tr_b16 v[36:37], v5 offset:26624
    ds_read_b64_tr_b16 v[38:39], v5 offset:27136
    ds_read_b128 v[40:43], v7 offset:16384
    ds_read_b128 v[44:47], v7 offset:20480
    s_add_u32 m0, s89, 0
    s_mov_b32 s80, 458880
    buffer_load_dwordx4 v2, s[64:67], s80 offen lds
    s_add_u32 m0, s89, 1024
    s_mov_b32 s80, 487552
    buffer_load_dwordx4 v2, s[64:67], s80 offen lds
    s_add_u32 m0, s89, 2048
    s_mov_b32 s80, 516224
    buffer_load_dwordx4 v2, s[64:67], s80 offen lds
    v_accvgpr_read_b32 v52, a0
    v_mfma_f32_32x32x16_bf16 a[80:95], v[16:19], v[28:31], a[80:95]
    v_accvgpr_read_b32 v53, a1
    v_accvgpr_read_b32 v54, a32
    v_accvgpr_read_b32 v55, a33
    v_cvt_pk_bf16_f32 v52, v52, v53
    v_cvt_pk_bf16_f32 v54, v54, v55
    v_lshlrev_b32 v56, 16, v52
    v_and_b32 v57, 0xffff0000, v52
    v_lshlrev_b32 v58, 16, v54
    v_and_b32 v59, 0xffff0000, v54
    v_mfma_f32_32x32x16_bf16 a[96:111], v[20:23], v[24:27], a[96:111]
    v_mul_f32 v56, v56, v58
    v_mul_f32 v57, v57, v59
    v_cvt_pk_bf16_f32 v50, v56, v57
    v_accvgpr_read_b32 v60, a2
    v_accvgpr_read_b32 v61, a3
    v_accvgpr_read_b32 v62, a34
    v_accvgpr_read_b32 v63, a35
    v_cvt_pk_bf16_f32 v60, v60, v61
    v_cvt_pk_bf16_f32 v62, v62, v63
    v_mfma_f32_32x32x16_bf16 a[112:127], v[20:23], v[28:31], a[112:127]
    v_lshlrev_b32 v64, 16, v60
    v_and_b32 v65, 0xffff0000, v60
    v_lshlrev_b32 v66, 16, v62
    v_and_b32 v67, 0xffff0000, v62
    v_mul_f32 v64, v64, v66
    v_mul_f32 v65, v65, v67
    v_cvt_pk_bf16_f32 v51, v64, v65
    ds_write_b64 v10, v[50:51] offset:0
    v_accvgpr_read_b32 v52, a4
    s_waitcnt lgkmcnt(0)
    v_mfma_f32_32x32x16_bf16 a[64:79], v[32:35], v[40:43], a[64:79]
    ds_read_b64_tr_b16 v[16:17], v5 offset:20480
    ds_read_b64_tr_b16 v[18:19], v5 offset:20992
    ds_read_b64_tr_b16 v[20:21], v5 offset:28672
    ds_read_b64_tr_b16 v[22:23], v5 offset:29184
    ds_read_b128 v[24:27], v8 offset:16384
    ds_read_b128 v[28:31], v8 offset:20480
    s_add_u32 m0, s89, 3072
    s_mov_b32 s80, 544896
    buffer_load_dwordx4 v2, s[64:67], s80 offen lds
    s_add_u32 m0, s89, 49152
    s_mov_b32 s80, 256
    buffer_load_dwordx4 v3, s[52:55], s80 offen sc1 lds
    s_add_u32 m0, s89, 50176
    s_mov_b32 s80, 7424
    buffer_load_dwordx4 v4, s[52:55], s80 offen sc1 lds
    v_accvgpr_read_b32 v53, a5
    v_mfma_f32_32x32x16_bf16 a[80:95], v[32:35], v[44:47], a[80:95]
    v_accvgpr_read_b32 v54, a36
    v_accvgpr_read_b32 v55, a37
    v_cvt_pk_bf16_f32 v52, v52, v53
    v_cvt_pk_bf16_f32 v54, v54, v55
    v_lshlrev_b32 v56, 16, v52
    v_and_b32 v57, 0xffff0000, v52
    v_lshlrev_b32 v58, 16, v54
    v_and_b32 v59, 0xffff0000, v54
    v_mul_f32 v56, v56, v58
    v_mfma_f32_32x32x16_bf16 a[96:111], v[36:39], v[40:43], a[96:111]
    v_mul_f32 v57, v57, v59
    v_cvt_pk_bf16_f32 v50, v56, v57
    v_accvgpr_read_b32 v60, a6
    v_accvgpr_read_b32 v61, a7
    v_accvgpr_read_b32 v62, a38
    v_accvgpr_read_b32 v63, a39
    v_cvt_pk_bf16_f32 v60, v60, v61
    v_cvt_pk_bf16_f32 v62, v62, v63
    v_lshlrev_b32 v64, 16, v60
    v_mfma_f32_32x32x16_bf16 a[112:127], v[36:39], v[44:47], a[112:127]
    v_and_b32 v65, 0xffff0000, v60
    v_lshlrev_b32 v66, 16, v62
    v_and_b32 v67, 0xffff0000, v62
    v_mul_f32 v64, v64, v66
    v_mul_f32 v65, v65, v67
    v_cvt_pk_bf16_f32 v51, v64, v65
    ds_write_b64 v10, v[50:51] offset:16
    v_accvgpr_read_b32 v52, a8
    v_accvgpr_read_b32 v53, a9
    s_waitcnt lgkmcnt(0)
    v_mfma_f32_32x32x16_bf16 a[64:79], v[16:19], v[24:27], a[64:79]
    ds_read_b64_tr_b16 v[32:33], v5 offset:22528
    ds_read_b64_tr_b16 v[34:35], v5 offset:23040
    ds_read_b64_tr_b16 v[36:37], v5 offset:30720
    ds_read_b64_tr_b16 v[38:39], v5 offset:31232
    ds_read_b128 v[40:43], v9 offset:16384
    ds_read_b128 v[44:47], v9 offset:20480
    s_add_u32 m0, s89, 51200
    s_mov_b32 s80, 14592
    buffer_load_dwordx4 v3, s[52:55], s80 offen sc1 lds
    s_add_u32 m0, s89, 52224
    s_mov_b32 s80, 21760
    buffer_load_dwordx4 v4, s[52:55], s80 offen sc1 lds
    v_accvgpr_read_b32 v54, a40
    v_mfma_f32_32x32x16_bf16 a[80:95], v[16:19], v[28:31], a[80:95]
    v_accvgpr_read_b32 v55, a41
    v_cvt_pk_bf16_f32 v52, v52, v53
    v_cvt_pk_bf16_f32 v54, v54, v55
    v_lshlrev_b32 v56, 16, v52
    v_and_b32 v57, 0xffff0000, v52
    v_lshlrev_b32 v58, 16, v54
    v_and_b32 v59, 0xffff0000, v54
    v_mul_f32 v56, v56, v58
    v_mul_f32 v57, v57, v59
    v_mfma_f32_32x32x16_bf16 a[96:111], v[20:23], v[24:27], a[96:111]
    v_cvt_pk_bf16_f32 v50, v56, v57
    v_accvgpr_read_b32 v60, a10
    v_accvgpr_read_b32 v61, a11
    v_accvgpr_read_b32 v62, a42
    v_accvgpr_read_b32 v63, a43
    v_cvt_pk_bf16_f32 v60, v60, v61
    v_cvt_pk_bf16_f32 v62, v62, v63
    v_lshlrev_b32 v64, 16, v60
    v_and_b32 v65, 0xffff0000, v60
    v_mfma_f32_32x32x16_bf16 a[112:127], v[20:23], v[28:31], a[112:127]
    v_lshlrev_b32 v66, 16, v62
    v_and_b32 v67, 0xffff0000, v62
    v_mul_f32 v64, v64, v66
    v_mul_f32 v65, v65, v67
    v_cvt_pk_bf16_f32 v51, v64, v65
    ds_write_b64 v10, v[50:51] offset:32
    v_accvgpr_read_b32 v52, a12
    v_accvgpr_read_b32 v53, a13
    v_accvgpr_read_b32 v54, a44
    s_waitcnt lgkmcnt(0)
    s_waitcnt vmcnt(8)
    v_mov_b32 v14, 152192
    v_mov_b32 v15, 1
    s_mov_b64 exec, 1
    ds_add_u32 v14, v15
    s_mov_b64 exec, -1
    v_mfma_f32_32x32x16_bf16 a[64:79], v[32:35], v[40:43], a[64:79]
    v_mfma_f32_32x32x16_bf16 a[80:95], v[32:35], v[44:47], a[80:95]
    v_accvgpr_read_b32 v55, a45
    v_cvt_pk_bf16_f32 v52, v52, v53
    v_cvt_pk_bf16_f32 v54, v54, v55
    v_lshlrev_b32 v56, 16, v52
    v_and_b32 v57, 0xffff0000, v52
    v_lshlrev_b32 v58, 16, v54
    v_and_b32 v59, 0xffff0000, v54
    v_mul_f32 v56, v56, v58
    v_mul_f32 v57, v57, v59
    v_cvt_pk_bf16_f32 v50, v56, v57
    v_accvgpr_read_b32 v60, a14
    v_accvgpr_read_b32 v61, a15
    v_accvgpr_read_b32 v62, a46
    v_accvgpr_read_b32 v63, a47
    v_cvt_pk_bf16_f32 v60, v60, v61
    v_cvt_pk_bf16_f32 v62, v62, v63
    v_lshlrev_b32 v64, 16, v60
    v_and_b32 v65, 0xffff0000, v60
    v_lshlrev_b32 v66, 16, v62
    v_and_b32 v67, 0xffff0000, v62
    v_mul_f32 v64, v64, v66
    v_mul_f32 v65, v65, v67
    v_cvt_pk_bf16_f32 v51, v64, v65
    ds_write_b64 v10, v[50:51] offset:48
GB_36:
    ds_read_b32 v15, v14
    s_waitcnt lgkmcnt(0)
    v_readfirstlane_b32 s84, v15
    s_nop 0
    s_cmp_ge_u32 s84, 44
    s_cbranch_scc0 GB_36
    v_mfma_f32_32x32x16_bf16 a[96:111], v[36:39], v[40:43], a[96:111]
    ds_read_b64_tr_b16 v[16:17], v5 offset:32768
    ds_read_b64_tr_b16 v[18:19], v5 offset:33280
    ds_read_b64_tr_b16 v[20:21], v5 offset:40960
    v_mfma_f32_32x32x16_bf16 a[112:127], v[36:39], v[44:47], a[112:127]
    ds_read_b64_tr_b16 v[22:23], v5 offset:41472
    ds_read_b128 v[24:27], v6 offset:32768
    ds_read_b128 v[28:31], v6 offset:36864
    s_waitcnt lgkmcnt(0)
    v_mfma_f32_32x32x16_bf16 a[64:79], v[16:19], v[24:27], a[64:79]
    ds_read_b64_tr_b16 v[32:33], v5 offset:34816
    ds_read_b64_tr_b16 v[34:35], v5 offset:35328
    ds_read_b64_tr_b16 v[36:37], v5 offset:43008
    v_mfma_f32_32x32x16_bf16 a[80:95], v[16:19], v[28:31], a[80:95]
    ds_read_b64_tr_b16 v[38:39], v5 offset:43520
    ds_read_b128 v[40:43], v7 offset:32768
    v_mfma_f32_32x32x16_bf16 a[96:111], v[20:23], v[24:27], a[96:111]
    ds_read_b128 v[44:47], v7 offset:36864
    s_add_u32 m0, s89, 16384
    s_mov_b32 s80, 688256
    buffer_load_dwordx4 v2, s[64:67], s80 offen lds
    v_mfma_f32_32x32x16_bf16 a[112:127], v[20:23], v[28:31], a[112:127]
    s_add_u32 m0, s89, 17408
    s_mov_b32 s80, 716928
    buffer_load_dwordx4 v2, s[64:67], s80 offen lds
    s_add_u32 m0, s89, 18432
    s_mov_b32 s80, 745600
    buffer_load_dwordx4 v2, s[64:67], s80 offen lds
    s_waitcnt lgkmcnt(0)
    ds_read_b128 v[68:71], v11 offset:0
    ds_read_b128 v[72:75], v11 offset:1280
    s_waitcnt lgkmcnt(0)
    s_mov_b32 s81, 0
    buffer_store_dwordx4 v[68:71], v48, s[72:75], s81 offen sc1
    s_nop 0
    s_mov_b32 s81, 1024
    buffer_store_dwordx4 v[72:75], v48, s[72:75], s81 offen sc1
    s_waitcnt lgkmcnt(0)
    v_mfma_f32_32x32x16_bf16 a[64:79], v[32:35], v[40:43], a[64:79]
    ds_read_b64_tr_b16 v[16:17], v5 offset:36864
    ds_read_b64_tr_b16 v[18:19], v5 offset:37376
    ds_read_b64_tr_b16 v[20:21], v5 offset:45056
    ds_read_b64_tr_b16 v[22:23], v5 offset:45568
    ds_read_b128 v[24:27], v8 offset:32768
    ds_read_b128 v[28:31], v8 offset:36864
    s_add_u32 m0, s89, 19456
    s_mov_b32 s80, 774272
    buffer_load_dwordx4 v2, s[64:67], s80 offen lds
    s_add_u32 m0, s89, 65536
    s_mov_b32 s80, 384
    buffer_load_dwordx4 v3, s[52:55], s80 offen sc1 lds
    s_add_u32 m0, s89, 66560
    s_mov_b32 s80, 7552
    buffer_load_dwordx4 v4, s[52:55], s80 offen sc1 lds
    v_accvgpr_read_b32 v52, a16
    v_mfma_f32_32x32x16_bf16 a[80:95], v[32:35], v[44:47], a[80:95]
    v_accvgpr_read_b32 v53, a17
    v_accvgpr_read_b32 v54, a48
    v_accvgpr_read_b32 v55, a49
    v_cvt_pk_bf16_f32 v52, v52, v53
    v_cvt_pk_bf16_f32 v54, v54, v55
    v_lshlrev_b32 v56, 16, v52
    v_and_b32 v57, 0xffff0000, v52
    v_lshlrev_b32 v58, 16, v54
    v_and_b32 v59, 0xffff0000, v54
    v_mfma_f32_32x32x16_bf16 a[96:111], v[36:39], v[40:43], a[96:111]
    v_mul_f32 v56, v56, v58
    v_mul_f32 v57, v57, v59
    v_cvt_pk_bf16_f32 v50, v56, v57
    v_accvgpr_read_b32 v60, a18
    v_accvgpr_read_b32 v61, a19
    v_accvgpr_read_b32 v62, a50
    v_accvgpr_read_b32 v63, a51
    v_cvt_pk_bf16_f32 v60, v60, v61
    v_cvt_pk_bf16_f32 v62, v62, v63
    v_mfma_f32_32x32x16_bf16 a[112:127], v[36:39], v[44:47], a[112:127]
    v_lshlrev_b32 v64, 16, v60
    v_and_b32 v65, 0xffff0000, v60
    v_lshlrev_b32 v66, 16, v62
    v_and_b32 v67, 0xffff0000, v62
    v_mul_f32 v64, v64, v66
    v_mul_f32 v65, v65, v67
    v_cvt_pk_bf16_f32 v51, v64, v65
    ds_write_b64 v10, v[50:51] offset:0
    v_accvgpr_read_b32 v52, a20
    s_waitcnt lgkmcnt(0)
    v_mfma_f32_32x32x16_bf16 a[64:79], v[16:19], v[24:27], a[64:79]
    ds_read_b64_tr_b16 v[32:33], v5 offset:38912
    ds_read_b64_tr_b16 v[34:35], v5 offset:39424
    ds_read_b64_tr_b16 v[36:37], v5 offset:47104
    ds_read_b64_tr_b16 v[38:39], v5 offset:47616
    ds_read_b128 v[40:43], v9 offset:32768
    ds_read_b128 v[44:47], v9 offset:36864
    s_add_u32 m0, s89, 67584
    s_mov_b32 s80, 14720
    buffer_load_dwordx4 v3, s[52:55], s80 offen sc1 lds
    s_add_u32 m0, s89, 68608
    s_mov_b32 s80, 21888
    buffer_load_dwordx4 v4, s[52:55], s80 offen sc1 lds
    v_accvgpr_read_b32 v53, a21
    v_mfma_f32_32x32x16_bf16 a[80:95], v[16:19], v[28:31], a[80:95]
    v_accvgpr_read_b32 v54, a52
    v_accvgpr_read_b32 v55, a53
    v_cvt_pk_bf16_f32 v52, v52, v53
    v_cvt_pk_bf16_f32 v54, v54, v55
    v_lshlrev_b32 v56, 16, v52
    v_and_b32 v57, 0xffff0000, v52
    v_lshlrev_b32 v58, 16, v54
    v_and_b32 v59, 0xffff0000, v54
    v_mul_f32 v56, v56, v58
    v_mfma_f32_32x32x16_bf16 a[96:111], v[20:23], v[24:27], a[96:111]
    v_mul_f32 v57, v57, v59
    v_cvt_pk_bf16_f32 v50, v56, v57
    v_accvgpr_read_b32 v60, a22
    v_accvgpr_read_b32 v61, a23
    v_accvgpr_read_b32 v62, a54
    v_accvgpr_read_b32 v63, a55
    v_cvt_pk_bf16_f32 v60, v60, v61
    v_cvt_pk_bf16_f32 v62, v62, v63
    v_lshlrev_b32 v64, 16, v60
    v_mfma_f32_32x32x16_bf16 a[112:127], v[20:23], v[28:31], a[112:127]
    v_and_b32 v65, 0xffff0000, v60
    v_lshlrev_b32 v66, 16, v62
    v_and_b32 v67, 0xffff0000, v62
    v_mul_f32 v64, v64, v66
    v_mul_f32 v65, v65, v67
    v_cvt_pk_bf16_f32 v51, v64, v65
    ds_write_b64 v10, v[50:51] offset:16
    v_accvgpr_read_b32 v52, a24
    v_accvgpr_read_b32 v53, a25
    s_waitcnt lgkmcnt(0)
    s_waitcnt vmcnt(10)
    v_mov_b32 v14, 152192
    v_mov_b32 v15, 1
    s_mov_b64 exec, 1
    ds_add_u32 v14, v15
    s_mov_b64 exec, -1
    v_mfma_f32_32x32x16_bf16 a[64:79], v[32:35], v[40:43], a[64:79]
    v_mfma_f32_32x32x16_bf16 a[80:95], v[32:35], v[44:47], a[80:95]
    v_accvgpr_read_b32 v54, a56
    v_accvgpr_read_b32 v55, a57
    v_cvt_pk_bf16_f32 v52, v52, v53
    v_cvt_pk_bf16_f32 v54, v54, v55
    v_lshlrev_b32 v56, 16, v52
    v_and_b32 v57, 0xffff0000, v52
    v_lshlrev_b32 v58, 16, v54
    v_and_b32 v59, 0xffff0000, v54
    v_mul_f32 v56, v56, v58
    v_mul_f32 v57, v57, v59
    v_cvt_pk_bf16_f32 v50, v56, v57
    v_accvgpr_read_b32 v60, a26
    v_accvgpr_read_b32 v61, a27
    v_accvgpr_read_b32 v62, a58
    v_accvgpr_read_b32 v63, a59
    v_cvt_pk_bf16_f32 v60, v60, v61
    v_cvt_pk_bf16_f32 v62, v62, v63
    v_lshlrev_b32 v64, 16, v60
    v_and_b32 v65, 0xffff0000, v60
    v_lshlrev_b32 v66, 16, v62
    v_and_b32 v67, 0xffff0000, v62
    v_mul_f32 v64, v64, v66
    v_mul_f32 v65, v65, v67
    v_cvt_pk_bf16_f32 v51, v64, v65
    ds_write_b64 v10, v[50:51] offset:32
    v_accvgpr_read_b32 v52, a28
    v_accvgpr_read_b32 v53, a29
    v_accvgpr_read_b32 v54, a60
GB_37:
    ds_read_b32 v15, v14
    s_waitcnt lgkmcnt(0)
    v_readfirstlane_b32 s84, v15
    s_nop 0
    s_cmp_ge_u32 s84, 48
    s_cbranch_scc0 GB_37
    v_mfma_f32_32x32x16_bf16 a[96:111], v[36:39], v[40:43], a[96:111]
    ds_read_b64_tr_b16 v[16:17], v5 offset:0
    ds_read_b64_tr_b16 v[18:19], v5 offset:512
    ds_read_b64_tr_b16 v[20:21], v5 offset:8192
    v_mfma_f32_32x32x16_bf16 a[112:127], v[36:39], v[44:47], a[112:127]
    ds_read_b64_tr_b16 v[22:23], v5 offset:8704
    ds_read_b128 v[24:27], v6 offset:0
    ds_read_b128 v[28:31], v6 offset:4096
    s_waitcnt lgkmcnt(0)
    v_mfma_f32_32x32x16_bf16 a[64:79], v[16:19], v[24:27], a[64:79]
    ds_read_b64_tr_b16 v[32:33], v5 offset:2048
    ds_read_b64_tr_b16 v[34:35], v5 offset:2560
    ds_read_b64_tr_b16 v[36:37], v5 offset:10240
    ds_read_b64_tr_b16 v[38:39], v5 offset:10752
    ds_read_b128 v[40:43], v7 offset:0
    ds_read_b128 v[44:47], v7 offset:4096
    s_add_u32 m0, s89, 32768
    s_mov_b32 s80, 917632
    buffer_load_dwordx4 v2, s[64:67], s80 offen lds
    s_add_u32 m0, s89, 33792
    s_mov_b32 s80, 946304
    buffer_load_dwordx4 v2, s[64:67], s80 offen lds
    s_add_u32 m0, s89, 34816
    s_mov_b32 s80, 974976
    buffer_load_dwordx4 v2, s[64:67], s80 offen lds
    v_mfma_f32_32x32x16_bf16 a[80:95], v[16:19], v[28:31], a[80:95]
    v_accvgpr_read_b32 v55, a61
    v_cvt_pk_bf16_f32 v52, v52, v53
    v_cvt_pk_bf16_f32 v54, v54, v55
    v_lshlrev_b32 v56, 16, v52
    v_and_b32 v57, 0xffff0000, v52
    v_lshlrev_b32 v58, 16, v54
    v_and_b32 v59, 0xffff0000, v54
    v_mul_f32 v56, v56, v58
    v_mfma_f32_32x32x16_bf16 a[96:111], v[20:23], v[24:27], a[96:111]
    v_mul_f32 v57, v57, v59
    v_cvt_pk_bf16_f32 v50, v56, v57
    v_accvgpr_read_b32 v60, a30
    v_accvgpr_read_b32 v61, a31
    v_accvgpr_read_b32 v62, a62
    v_accvgpr_read_b32 v63, a63
    v_cvt_pk_bf16_f32 v60, v60, v61
    v_cvt_pk_bf16_f32 v62, v62, v63
    v_mfma_f32_32x32x16_bf16 a[112:127], v[20:23], v[28:31], a[112:127]
    v_lshlrev_b32 v64, 16, v60
    v_and_b32 v65, 0xffff0000, v60
    v_lshlrev_b32 v66, 16, v62
    v_and_b32 v67, 0xffff0000, v62
    v_mul_f32 v64, v64, v66
    v_mul_f32 v65, v65, v67
    v_cvt_pk_bf16_f32 v51, v64, v65
    ds_write_b64 v10, v[50:51] offset:48
    s_waitcnt lgkmcnt(0)
    v_mfma_f32_32x32x16_bf16 a[64:79], v[32:35], v[40:43], a[64:79]
    ds_read_b64_tr_b16 v[16:17], v5 offset:4096
    ds_read_b64_tr_b16 v[18:19], v5 offset:4608
    ds_read_b64_tr_b16 v[20:21], v5 offset:12288
    v_mfma_f32_32x32x16_bf16 a[80:95], v[32:35], v[44:47], a[80:95]
    ds_read_b64_tr_b16 v[22:23], v5 offset:12800
    ds_read_b128 v[24:27], v8 offset:0
    v_mfma_f32_32x32x16_bf16 a[96:111], v[36:39], v[40:43], a[96:111]
    ds_read_b128 v[28:31], v8 offset:4096
    s_add_u32 m0, s89, 35840
    s_mov_b32 s80, 1003648
    buffer_load_dwordx4 v2, s[64:67], s80 offen lds
    v_mfma_f32_32x32x16_bf16 a[112:127], v[36:39], v[44:47], a[112:127]
    s_add_u32 m0, s89, 81920
    s_mov_b32 s80, 512
    buffer_load_dwordx4 v3, s[52:55], s80 offen sc1 lds
    s_add_u32 m0, s89, 82944
    s_mov_b32 s80, 7680
    buffer_load_dwordx4 v4, s[52:55], s80 offen sc1 lds
    s_waitcnt lgkmcnt(0)
    ds_read_b128 v[76:79], v11 offset:0
    ds_read_b128 v[80:83], v11 offset:1280
    s_waitcnt lgkmcnt(0)
    s_mov_b32 s81, 2048
    buffer_store_dwordx4 v[76:79], v48, s[72:75], s81 offen sc1
    s_nop 0
    s_mov_b32 s81, 3072
    buffer_store_dwordx4 v[80:83], v48, s[72:75], s81 offen sc1
    s_waitcnt lgkmcnt(0)
    v_mfma_f32_32x32x16_bf16 a[64:79], v[16:19], v[24:27], a[64:79]
    ds_read_b64_tr_b16 v[32:33], v5 offset:6144
    ds_read_b64_tr_b16 v[34:35], v5 offset:6656
    v_mfma_f32_32x32x16_bf16 a[80:95], v[16:19], v[28:31], a[80:95]
    ds_read_b64_tr_b16 v[36:37], v5 offset:14336
    ds_read_b64_tr_b16 v[38:39], v5 offset:14848
    v_mfma_f32_32x32x16_bf16 a[96:111], v[20:23], v[24:27], a[96:111]
    ds_read_b128 v[40:43], v9 offset:0
    ds_read_b128 v[44:47], v9 offset:4096
    v_mfma_f32_32x32x16_bf16 a[112:127], v[20:23], v[28:31], a[112:127]
    s_add_u32 m0, s89, 83968
    s_mov_b32 s80, 14848
    buffer_load_dwordx4 v3, s[52:55], s80 offen sc1 lds
    s_add_u32 m0, s89, 84992
    s_mov_b32 s80, 22016
    buffer_load_dwordx4 v4, s[52:55], s80 offen sc1 lds
    s_waitcnt lgkmcnt(0)
    s_waitcnt vmcnt(10)
    v_mov_b32 v14, 152192
    v_mov_b32 v15, 1
    s_mov_b64 exec, 1
    ds_add_u32 v14, v15
    s_mov_b64 exec, -1
    v_mfma_f32_32x32x16_bf16 a[64:79], v[32:35], v[40:43], a[64:79]
    v_mfma_f32_32x32x16_bf16 a[80:95], v[32:35], v[44:47], a[80:95]
GB_38:
    ds_read_b32 v15, v14
    s_waitcnt lgkmcnt(0)
    v_readfirstlane_b32 s84, v15
    s_nop 0
    s_cmp_ge_u32 s84, 52
    s_cbranch_scc0 GB_38
    v_mfma_f32_32x32x16_bf16 a[96:111], v[36:39], v[40:43], a[96:111]
    ds_read_b64_tr_b16 v[16:17], v5 offset:16384
    ds_read_b64_tr_b16 v[18:19], v5 offset:16896
    ds_read_b64_tr_b16 v[20:21], v5 offset:24576
    v_mfma_f32_32x32x16_bf16 a[112:127], v[36:39], v[44:47], a[112:127]
    ds_read_b64_tr_b16 v[22:23], v5 offset:25088
    ds_read_b128 v[24:27], v6 offset:16384
    ds_read_b128 v[28:31], v6 offset:20480
    s_waitcnt lgkmcnt(0)
    v_mfma_f32_32x32x16_bf16 a[64:79], v[16:19], v[24:27], a[64:79]
    ds_read_b64_tr_b16 v[32:33], v5 offset:18432
    ds_read_b64_tr_b16 v[34:35], v5 offset:18944
    ds_read_b64_tr_b16 v[36:37], v5 offset:26624
    v_mfma_f32_32x32x16_bf16 a[80:95], v[16:19], v[28:31], a[80:95]
    ds_read_b64_tr_b16 v[38:39], v5 offset:27136
    ds_read_b128 v[40:43], v7 offset:16384
    v_mfma_f32_32x32x16_bf16 a[96:111], v[20:23], v[24:27], a[96:111]
    ds_read_b128 v[44:47], v7 offset:20480
    s_add_u32 m0, s89, 0
    s_mov_b32 s80, 1147008
    buffer_load_dwordx4 v2, s[64:67], s80 offen lds
    v_mfma_f32_32x32x16_bf16 a[112:127], v[20:23], v[28:31], a[112:127]
    s_add_u32 m0, s89, 1024
    s_mov_b32 s80, 1175680
    buffer_load_dwordx4 v2, s[64:67], s80 offen lds
    s_add_u32 m0, s89, 2048
    s_mov_b32 s80, 1204352
    buffer_load_dwordx4 v2, s[64:67], s80 offen lds
    s_waitcnt lgkmcnt(0)
    v_mfma_f32_32x32x16_bf16 a[64:79], v[32:35], v[40:43], a[64:79]
    ds_read_b64_tr_b16 v[16:17], v5 offset:20480
    ds_read_b64_tr_b16 v[18:19], v5 offset:20992
    ds_read_b64_tr_b16 v[20:21], v5 offset:28672
    v_mfma_f32_32x32x16_bf16 a[80:95], v[32:35], v[44:47], a[80:95]
    ds_read_b64_tr_b16 v[22:23], v5 offset:29184
    ds_read_b128 v[24:27], v8 offset:16384
    v_mfma_f32_32x32x16_bf16 a[96:111], v[36:39], v[40:43], a[96:111]
    ds_read_b128 v[28:31], v8 offset:20480
    s_add_u32 m0, s89, 3072
    s_mov_b32 s80, 1233024
    buffer_load_dwordx4 v2, s[64:67], s80 offen lds
    v_mfma_f32_32x32x16_bf16 a[112:127], v[36:39], v[44:47], a[112:127]
    s_add_u32 m0, s89, 49152
    s_mov_b32 s80, 640
    buffer_load_dwordx4 v3, s[52:55], s80 offen sc1 lds
    s_add_u32 m0, s89, 50176
    s_mov_b32 s80, 7808
    buffer_load_dwordx4 v4, s[52:55], s80 offen sc1 lds
    s_waitcnt lgkmcnt(0)
    v_mfma_f32_32x32x16_bf16 a[64:79], v[16:19], v[24:27], a[64:79]
    ds_read_b64_tr_b16 v[32:33], v5 offset:22528
    ds_read_b64_tr_b16 v[34:35], v5 offset:23040
    v_mfma_f32_32x32x16_bf16 a[80:95], v[16:19], v[28:31], a[80:95]
    ds_read_b64_tr_b16 v[36:37], v5 offset:30720
    ds_read_b64_tr_b16 v[38:39], v5 offset:31232
    v_mfma_f32_32x32x16_bf16 a[96:111], v[20:23], v[24:27], a[96:111]
    ds_read_b128 v[40:43], v9 offset:16384
    ds_read_b128 v[44:47], v9 offset:20480
    v_mfma_f32_32x32x16_bf16 a[112:127], v[20:23], v[28:31], a[112:127]
    s_add_u32 m0, s89, 51200
    s_mov_b32 s80, 14976
    buffer_load_dwordx4 v3, s[52:55], s80 offen sc1 lds
    s_add_u32 m0, s89, 52224
    s_mov_b32 s80, 22144
    buffer_load_dwordx4 v4, s[52:55], s80 offen sc1 lds
    s_waitcnt lgkmcnt(0)
    s_waitcnt vmcnt(8)
    v_mov_b32 v14, 152192
    v_mov_b32 v15, 1
    s_mov_b64 exec, 1
    ds_add_u32 v14, v15
    s_mov_b64 exec, -1
    v_mfma_f32_32x32x16_bf16 a[64:79], v[32:35], v[40:43], a[64:79]
    v_mfma_f32_32x32x16_bf16 a[80:95], v[32:35], v[44:47], a[80:95]
GB_39:
    ds_read_b32 v15, v14
    s_waitcnt lgkmcnt(0)
    v_readfirstlane_b32 s84, v15
    s_nop 0
    s_cmp_ge_u32 s84, 56
    s_cbranch_scc0 GB_39
    v_mfma_f32_32x32x16_bf16 a[96:111], v[36:39], v[40:43], a[96:111]
    ds_read_b64_tr_b16 v[16:17], v5 offset:32768
    ds_read_b64_tr_b16 v[18:19], v5 offset:33280
    ds_read_b64_tr_b16 v[20:21], v5 offset:40960
    v_mfma_f32_32x32x16_bf16 a[112:127], v[36:39], v[44:47], a[112:127]
    ds_read_b64_tr_b16 v[22:23], v5 offset:41472
    ds_read_b128 v[24:27], v6 offset:32768
    ds_read_b128 v[28:31], v6 offset:36864
    s_waitcnt lgkmcnt(0)
    v_mfma_f32_32x32x16_bf16 a[64:79], v[16:19], v[24:27], a[64:79]
    ds_read_b64_tr_b16 v[32:33], v5 offset:34816
    ds_read_b64_tr_b16 v[34:35], v5 offset:35328
    ds_read_b64_tr_b16 v[36:37], v5 offset:43008
    v_mfma_f32_32x32x16_bf16 a[80:95], v[16:19], v[28:31], a[80:95]
    ds_read_b64_tr_b16 v[38:39], v5 offset:43520
    ds_read_b128 v[40:43], v7 offset:32768
    v_mfma_f32_32x32x16_bf16 a[96:111], v[20:23], v[24:27], a[96:111]
    ds_read_b128 v[44:47], v7 offset:36864
    s_add_u32 m0, s89, 16384
    s_mov_b32 s80, 1376384
    buffer_load_dwordx4 v2, s[64:67], s80 offen lds
    v_mfma_f32_32x32x16_bf16 a[112:127], v[20:23], v[28:31], a[112:127]
    s_add_u32 m0, s89, 17408
    s_mov_b32 s80, 1405056
    buffer_load_dwordx4 v2, s[64:67], s80 offen lds
    s_add_u32 m0, s89, 18432
    s_mov_b32 s80, 1433728
    buffer_load_dwordx4 v2, s[64:67], s80 offen lds
    v_mov_b32 v14, 152256
    v_mov_b32 v15, 1
    s_mov_b64 exec, 1
    ds_add_rtn_u32 v15, v14, v15
    s_mov_b64 exec, -1
    s_waitcnt lgkmcnt(0)
    v_readfirstlane_b32 s84, v15
    s_nop 0
    s_cmp_lg_u32 s84, 3
    s_cbranch_scc1 HS_40
    s_add_u32 s82, s2, 256
    s_lshl_b32 s82, s82, 7
    v_mov_b32 v14, s82
    v_mov_b32 v64, s12
    v_mov_b32 v65, s13
    s_mov_b64 exec, 1
    buffer_store_dwordx2 v[64:65], v14, s[8:11], 0 offen sc0 sc1
    s_mov_b64 exec, -1
HS_40:
    s_waitcnt lgkmcnt(0)
    v_mfma_f32_32x32x16_bf16 a[64:79], v[32:35], v[40:43], a[64:79]
    ds_read_b64_tr_b16 v[16:17], v5 offset:36864
    ds_read_b64_tr_b16 v[18:19], v5 offset:37376
    ds_read_b64_tr_b16 v[20:21], v5 offset:45056
    v_mfma_f32_32x32x16_bf16 a[80:95], v[32:35], v[44:47], a[80:95]
    ds_read_b64_tr_b16 v[22:23], v5 offset:45568
    ds_read_b128 v[24:27], v8 offset:32768
    v_mfma_f32_32x32x16_bf16 a[96:111], v[36:39], v[40:43], a[96:111]
    ds_read_b128 v[28:31], v8 offset:36864
    s_add_u32 m0, s89, 19456
    s_mov_b32 s80, 1462400
    buffer_load_dwordx4 v2, s[64:67], s80 offen lds
    v_mfma_f32_32x32x16_bf16 a[112:127], v[36:39], v[44:47], a[112:127]
    s_add_u32 m0, s89, 65536
    s_mov_b32 s80, 768
    buffer_load_dwordx4 v3, s[52:55], s80 offen sc1 lds
    s_add_u32 m0, s89, 66560
    s_mov_b32 s80, 7936
    buffer_load_dwordx4 v4, s[52:55], s80 offen sc1 lds
    s_waitcnt lgkmcnt(0)
    v_mfma_f32_32x32x16_bf16 a[64:79], v[16:19], v[24:27], a[64:79]
    ds_read_b64_tr_b16 v[32:33], v5 offset:38912
    ds_read_b64_tr_b16 v[34:35], v5 offset:39424
    v_mfma_f32_32x32x16_bf16 a[80:95], v[16:19], v[28:31], a[80:95]
    ds_read_b64_tr_b16 v[36:37], v5 offset:47104
    ds_read_b64_tr_b16 v[38:39], v5 offset:47616
    v_mfma_f32_32x32x16_bf16 a[96:111], v[20:23], v[24:27], a[96:111]
    ds_read_b128 v[40:43], v9 offset:32768
    ds_read_b128 v[44:47], v9 offset:36864
    v_mfma_f32_32x32x16_bf16 a[112:127], v[20:23], v[28:31], a[112:127]
    s_add_u32 m0, s89, 67584
    s_mov_b32 s80, 15104
    buffer_load_dwordx4 v3, s[52:55], s80 offen sc1 lds
    s_add_u32 m0, s89, 68608
    s_mov_b32 s80, 22272
    buffer_load_dwordx4 v4, s[52:55], s80 offen sc1 lds
    s_waitcnt lgkmcnt(0)
    s_waitcnt vmcnt(8)
    v_mov_b32 v14, 152192
    v_mov_b32 v15, 1
    s_mov_b64 exec, 1
    ds_add_u32 v14, v15
    s_mov_b64 exec, -1
    v_mfma_f32_32x32x16_bf16 a[64:79], v[32:35], v[40:43], a[64:79]
    v_mfma_f32_32x32x16_bf16 a[80:95], v[32:35], v[44:47], a[80:95]
GB_41:
    ds_read_b32 v15, v14
    s_waitcnt lgkmcnt(0)
    v_readfirstlane_b32 s84, v15
    s_nop 0
    s_cmp_ge_u32 s84, 60
    s_cbranch_scc0 GB_41
    v_mfma_f32_32x32x16_bf16 a[96:111], v[36:39], v[40:43], a[96:111]
    ds_read_b64_tr_b16 v[16:17], v5 offset:0
    ds_read_b64_tr_b16 v[18:19], v5 offset:512
    ds_read_b64_tr_b16 v[20:21], v5 offset:8192
    v_mfma_f32_32x32x16_bf16 a[112:127], v[36:39], v[44:47], a[112:127]
    ds_read_b64_tr_b16 v[22:23], v5 offset:8704
    ds_read_b128 v[24:27], v6 offset:0
    ds_read_b128 v[28:31], v6 offset:4096
    s_waitcnt lgkmcnt(0)
    v_mfma_f32_32x32x16_bf16 a[64:79], v[16:19], v[24:27], a[64:79]
    ds_read_b64_tr_b16 v[32:33], v5 offset:2048
    ds_read_b64_tr_b16 v[34:35], v5 offset:2560
    v_mfma_f32_32x32x16_bf16 a[80:95], v[16:19], v[28:31], a[80:95]
    ds_read_b64_tr_b16 v[36:37], v5 offset:10240
    v_mfma_f32_32x32x16_bf16 a[96:111], v[20:23], v[24:27], a[96:111]
    ds_read_b64_tr_b16 v[38:39], v5 offset:10752
    ds_read_b128 v[40:43], v7 offset:0
    v_mfma_f32_32x32x16_bf16 a[112:127], v[20:23], v[28:31], a[112:127]
    ds_read_b128 v[44:47], v7 offset:4096
    s_waitcnt lgkmcnt(0)
    v_mfma_f32_32x32x16_bf16 a[64:79], v[32:35], v[40:43], a[64:79]
    ds_read_b64_tr_b16 v[16:17], v5 offset:4096
    ds_read_b64_tr_b16 v[18:19], v5 offset:4608
    v_mfma_f32_32x32x16_bf16 a[80:95], v[32:35], v[44:47], a[80:95]
    ds_read_b64_tr_b16 v[20:21], v5 offset:12288
    v_mfma_f32_32x32x16_bf16 a[96:111], v[36:39], v[40:43], a[96:111]
    ds_read_b64_tr_b16 v[22:23], v5 offset:12800
    ds_read_b128 v[24:27], v8 offset:0
    v_mfma_f32_32x32x16_bf16 a[112:127], v[36:39], v[44:47], a[112:127]
    ds_read_b128 v[28:31], v8 offset:4096
    s_waitcnt lgkmcnt(0)
    v_mfma_f32_32x32x16_bf16 a[64:79], v[16:19], v[24:27], a[64:79]
    ds_read_b64_tr_b16 v[32:33], v5 offset:6144
    ds_read_b64_tr_b16 v[34:35], v5 offset:6656
    v_mfma_f32_32x32x16_bf16 a[80:95], v[16:19], v[28:31], a[80:95]
    ds_read_b64_tr_b16 v[36:37], v5 offset:14336
    v_mfma_f32_32x32x16_bf16 a[96:111], v[20:23], v[24:27], a[96:111]
    ds_read_b64_tr_b16 v[38:39], v5 offset:14848
    ds_read_b128 v[40:43], v9 offset:0
    v_mfma_f32_32x32x16_bf16 a[112:127], v[20:23], v[28:31], a[112:127]
    ds_read_b128 v[44:47], v9 offset:4096
    s_waitcnt lgkmcnt(0)
    s_waitcnt vmcnt(0)
    v_mov_b32 v14, 152192
    v_mov_b32 v15, 1
    s_mov_b64 exec, 1
    ds_add_u32 v14, v15
    s_mov_b64 exec, -1
    v_mfma_f32_32x32x16_bf16 a[64:79], v[32:35], v[40:43], a[64:79]
    v_mfma_f32_32x32x16_bf16 a[80:95], v[32:35], v[44:47], a[80:95]
GB_42:
    ds_read_b32 v15, v14
    s_waitcnt lgkmcnt(0)
    v_readfirstlane_b32 s84, v15
    s_nop 0
    s_cmp_ge_u32 s84, 64
    s_cbranch_scc0 GB_42
    v_mfma_f32_32x32x16_bf16 a[96:111], v[36:39], v[40:43], a[96:111]
    ds_read_b64_tr_b16 v[16:17], v5 offset:16384
    ds_read_b64_tr_b16 v[18:19], v5 offset:16896
    ds_read_b64_tr_b16 v[20:21], v5 offset:24576
    v_mfma_f32_32x32x16_bf16 a[112:127], v[36:39], v[44:47], a[112:127]
    ds_read_b64_tr_b16 v[22:23], v5 offset:25088
    ds_read_b128 v[24:27], v6 offset:16384
    ds_read_b128 v[28:31], v6 offset:20480
    s_waitcnt lgkmcnt(0)
    v_mfma_f32_32x32x16_bf16 a[64:79], v[16:19], v[24:27], a[64:79]
    ds_read_b64_tr_b16 v[32:33], v5 offset:18432
    ds_read_b64_tr_b16 v[34:35], v5 offset:18944
    v_mfma_f32_32x32x16_bf16 a[80:95], v[16:19], v[28:31], a[80:95]
    ds_read_b64_tr_b16 v[36:37], v5 offset:26624
    v_mfma_f32_32x32x16_bf16 a[96:111], v[20:23], v[24:27], a[96:111]
    ds_read_b64_tr_b16 v[38:39], v5 offset:27136
    ds_read_b128 v[40:43], v7 offset:16384
    v_mfma_f32_32x32x16_bf16 a[112:127], v[20:23], v[28:31], a[112:127]
    ds_read_b128 v[44:47], v7 offset:20480
    s_lshr_b32 s80, s87, 1
    s_and_b32 s81, s80, 3
    s_lshr_b32 s80, s80, 2
    s_mul_i32 s81, s81, 56
    s_lshl_b32 s80, s80, 1
    s_add_u32 s80, s80, s81
    s_add_u32 s80, s80, 256
    v_lshrrev_b32 v84, 1, v1
    v_lshlrev_b32 v84, 3, v84
    v_and_b32 v85, 1, v1
    v_add_u32 v84, v84, v85
    v_add_u32 v84, s80, v84
    v_mov_b32 v85, 2000
    v_cmp_gt_u32 vcc, 14, v1
    s_nop 1
    v_cndmask_b32 v84, v85, v84, vcc
    v_lshlrev_b32 v84, 7, v84
    buffer_load_dwordx2 v[86:87], v84, s[8:11], 0 offen sc0 sc1
    s_waitcnt lgkmcnt(0)
    v_mfma_f32_32x32x16_bf16 a[64:79], v[32:35], v[40:43], a[64:79]
    ds_read_b64_tr_b16 v[16:17], v5 offset:20480
    ds_read_b64_tr_b16 v[18:19], v5 offset:20992
    v_mfma_f32_32x32x16_bf16 a[80:95], v[32:35], v[44:47], a[80:95]
    ds_read_b64_tr_b16 v[20:21], v5 offset:28672
    v_mfma_f32_32x32x16_bf16 a[96:111], v[36:39], v[40:43], a[96:111]
    ds_read_b64_tr_b16 v[22:23], v5 offset:29184
    ds_read_b128 v[24:27], v8 offset:16384
    v_mfma_f32_32x32x16_bf16 a[112:127], v[36:39], v[44:47], a[112:127]
    ds_read_b128 v[28:31], v8 offset:20480
    s_waitcnt lgkmcnt(0)
    v_mfma_f32_32x32x16_bf16 a[64:79], v[16:19], v[24:27], a[64:79]
    ds_read_b64_tr_b16 v[32:33], v5 offset:22528
    ds_read_b64_tr_b16 v[34:35], v5 offset:23040
    v_mfma_f32_32x32x16_bf16 a[80:95], v[16:19], v[28:31], a[80:95]
    ds_read_b64_tr_b16 v[36:37], v5 offset:30720
    v_mfma_f32_32x32x16_bf16 a[96:111], v[20:23], v[24:27], a[96:111]
    ds_read_b64_tr_b16 v[38:39], v5 offset:31232
    ds_read_b128 v[40:43], v9 offset:16384
    v_mfma_f32_32x32x16_bf16 a[112:127], v[20:23], v[28:31], a[112:127]
    ds_read_b128 v[44:47], v9 offset:20480
    s_waitcnt lgkmcnt(0)
    v_mfma_f32_32x32x16_bf16 a[64:79], v[32:35], v[40:43], a[64:79]
    v_mfma_f32_32x32x16_bf16 a[80:95], v[32:35], v[44:47], a[80:95]
    v_mfma_f32_32x32x16_bf16 a[96:111], v[36:39], v[40:43], a[96:111]
    v_mfma_f32_32x32x16_bf16 a[112:127], v[36:39], v[44:47], a[112:127]
    v_mov_b32 v14, 152192
    v_mov_b32 v15, 1
    s_mov_b64 exec, 1
    ds_add_u32 v14, v15
    s_mov_b64 exec, -1
    s_nop 3
    v_accvgpr_read_b32 v52, a64
    v_accvgpr_read_b32 v53, a65
    v_accvgpr_read_b32 v54, a96
    v_accvgpr_read_b32 v55, a97
    v_cvt_pk_bf16_f32 v52, v52, v53
    v_cvt_pk_bf16_f32 v54, v54, v55
    v_lshlrev_b32 v56, 16, v52
    v_and_b32 v57, 0xffff0000, v52
    v_lshlrev_b32 v58, 16, v54
    v_and_b32 v59, 0xffff0000, v54
    v_mul_f32 v56, v56, v58
    v_mul_f32 v57, v57, v59
    v_cvt_pk_bf16_f32 v50, v56, v57
    v_accvgpr_read_b32 v60, a66
    v_accvgpr_read_b32 v61, a67
    v_accvgpr_read_b32 v62, a98
    v_accvgpr_read_b32 v63, a99
    v_cvt_pk_bf16_f32 v60, v60, v61
    v_cvt_pk_bf16_f32 v62, v62, v63
    v_lshlrev_b32 v64, 16, v60
    v_and_b32 v65, 0xffff0000, v60
    v_lshlrev_b32 v66, 16, v62
    v_and_b32 v67, 0xffff0000, v62
    v_mul_f32 v64, v64, v66
    v_mul_f32 v65, v65, v67
    v_cvt_pk_bf16_f32 v51, v64, v65
    ds_write_b64 v10, v[50:51] offset:0
    v_accvgpr_read_b32 v52, a68
    v_accvgpr_read_b32 v53, a69
    v_accvgpr_read_b32 v54, a100
    v_accvgpr_read_b32 v55, a101
    v_cvt_pk_bf16_f32 v52, v52, v53
    v_cvt_pk_bf16_f32 v54, v54, v55
    v_lshlrev_b32 v56, 16, v52
    v_and_b32 v57, 0xffff0000, v52
    v_lshlrev_b32 v58, 16, v54
    v_and_b32 v59, 0xffff0000, v54
    v_mul_f32 v56, v56, v58
    v_mul_f32 v57, v57, v59
    v_cvt_pk_bf16_f32 v50, v56, v57
    v_accvgpr_read_b32 v60, a70
    v_accvgpr_read_b32 v61, a71
    v_accvgpr_read_b32 v62, a102
    v_accvgpr_read_b32 v63, a103
    v_cvt_pk_bf16_f32 v60, v60, v61
    v_cvt_pk_bf16_f32 v62, v62, v63
    v_lshlrev_b32 v64, 16, v60
    v_and_b32 v65, 0xffff0000, v60
    v_lshlrev_b32 v66, 16, v62
    v_and_b32 v67, 0xffff0000, v62
    v_mul_f32 v64, v64, v66
    v_mul_f32 v65, v65, v67
    v_cvt_pk_bf16_f32 v51, v64, v65
    ds_write_b64 v10, v[50:51] offset:16
    v_accvgpr_read_b32 v52, a72
    v_accvgpr_read_b32 v53, a73
    v_accvgpr_read_b32 v54, a104
    v_accvgpr_read_b32 v55, a105
    v_cvt_pk_bf16_f32 v52, v52, v53
    v_cvt_pk_bf16_f32 v54, v54, v55
    v_lshlrev_b32 v56, 16, v52
    v_and_b32 v57, 0xffff0000, v52
    v_lshlrev_b32 v58, 16, v54
    v_and_b32 v59, 0xffff0000, v54
    v_mul_f32 v56, v56, v58
    v_mul_f32 v57, v57, v59
    v_cvt_pk_bf16_f32 v50, v56, v57
    v_accvgpr_read_b32 v60, a74
    v_accvgpr_read_b32 v61, a75
    v_accvgpr_read_b32 v62, a106
    v_accvgpr_read_b32 v63, a107
    v_cvt_pk_bf16_f32 v60, v60, v61
    v_cvt_pk_bf16_f32 v62, v62, v63
    v_lshlrev_b32 v64, 16, v60
    v_and_b32 v65, 0xffff0000, v60
    v_lshlrev_b32 v66, 16, v62
    v_and_b32 v67, 0xffff0000, v62
    v_mul_f32 v64, v64, v66
    v_mul_f32 v65, v65, v67
    v_cvt_pk_bf16_f32 v51, v64, v65
    ds_write_b64 v10, v[50:51] offset:32
    v_accvgpr_read_b32 v52, a76
    v_accvgpr_read_b32 v53, a77
    v_accvgpr_read_b32 v54, a108
    v_accvgpr_read_b32 v55, a109
    v_cvt_pk_bf16_f32 v52, v52, v53
    v_cvt_pk_bf16_f32 v54, v54, v55
    v_lshlrev_b32 v56, 16, v52
    v_and_b32 v57, 0xffff0000, v52
    v_lshlrev_b32 v58, 16, v54
    v_and_b32 v59, 0xffff0000, v54
    v_mul_f32 v56, v56, v58
    v_mul_f32 v57, v57, v59
    v_cvt_pk_bf16_f32 v50, v56, v57
    v_accvgpr_read_b32 v60, a78
    v_accvgpr_read_b32 v61, a79
    v_accvgpr_read_b32 v62, a110
    v_accvgpr_read_b32 v63, a111
    v_cvt_pk_bf16_f32 v60, v60, v61
    v_cvt_pk_bf16_f32 v62, v62, v63
    v_lshlrev_b32 v64, 16, v60
    v_and_b32 v65, 0xffff0000, v60
    v_lshlrev_b32 v66, 16, v62
    v_and_b32 v67, 0xffff0000, v62
    v_mul_f32 v64, v64, v66
    v_mul_f32 v65, v65, v67
    v_cvt_pk_bf16_f32 v51, v64, v65
    ds_write_b64 v10, v[50:51] offset:48
    s_waitcnt lgkmcnt(0)
    ds_read_b128 v[68:71], v11 offset:0
    ds_read_b128 v[72:75], v11 offset:1280
    s_waitcnt lgkmcnt(0)
    s_mov_b32 s81, 16384
    buffer_store_dwordx4 v[68:71], v48, s[72:75], s81 offen sc1
    s_nop 0
    s_mov_b32 s81, 17408
    buffer_store_dwordx4 v[72:75], v48, s[72:75], s81 offen sc1
    v_accvgpr_read_b32 v52, a80
    v_accvgpr_read_b32 v53, a81
    v_accvgpr_read_b32 v54, a112
    v_accvgpr_read_b32 v55, a113
    v_cvt_pk_bf16_f32 v52, v52, v53
    v_cvt_pk_bf16_f32 v54, v54, v55
    v_lshlrev_b32 v56, 16, v52
    v_and_b32 v57, 0xffff0000, v52
    v_lshlrev_b32 v58, 16, v54
    v_and_b32 v59, 0xffff0000, v54
    v_mul_f32 v56, v56, v58
    v_mul_f32 v57, v57, v59
    v_cvt_pk_bf16_f32 v50, v56, v57
    v_accvgpr_read_b32 v60, a82
    v_accvgpr_read_b32 v61, a83
    v_accvgpr_read_b32 v62, a114
    v_accvgpr_read_b32 v63, a115
    v_cvt_pk_bf16_f32 v60, v60, v61
    v_cvt_pk_bf16_f32 v62, v62, v63
    v_lshlrev_b32 v64, 16, v60
    v_and_b32 v65, 0xffff0000, v60
    v_lshlrev_b32 v66, 16, v62
    v_and_b32 v67, 0xffff0000, v62
    v_mul_f32 v64, v64, v66
    v_mul_f32 v65, v65, v67
    v_cvt_pk_bf16_f32 v51, v64, v65
    ds_write_b64 v10, v[50:51] offset:0
    v_accvgpr_read_b32 v52, a84
    v_accvgpr_read_b32 v53, a85
    v_accvgpr_read_b32 v54, a116
    v_accvgpr_read_b32 v55, a117
    v_cvt_pk_bf16_f32 v52, v52, v53
    v_cvt_pk_bf16_f32 v54, v54, v55
    v_lshlrev_b32 v56, 16, v52
    v_and_b32 v57, 0xffff0000, v52
    v_lshlrev_b32 v58, 16, v54
    v_and_b32 v59, 0xffff0000, v54
    v_mul_f32 v56, v56, v58
    v_mul_f32 v57, v57, v59
    v_cvt_pk_bf16_f32 v50, v56, v57
    v_accvgpr_read_b32 v60, a86
    v_accvgpr_read_b32 v61, a87
    v_accvgpr_read_b32 v62, a118
    v_accvgpr_read_b32 v63, a119
    v_cvt_pk_bf16_f32 v60, v60, v61
    v_cvt_pk_bf16_f32 v62, v62, v63
    v_lshlrev_b32 v64, 16, v60
    v_and_b32 v65, 0xffff0000, v60
    v_lshlrev_b32 v66, 16, v62
    v_and_b32 v67, 0xffff0000, v62
    v_mul_f32 v64, v64, v66
    v_mul_f32 v65, v65, v67
    v_cvt_pk_bf16_f32 v51, v64, v65
    ds_write_b64 v10, v[50:51] offset:16
    v_accvgpr_read_b32 v52, a88
    v_accvgpr_read_b32 v53, a89
    v_accvgpr_read_b32 v54, a120
    v_accvgpr_read_b32 v55, a121
    v_cvt_pk_bf16_f32 v52, v52, v53
    v_cvt_pk_bf16_f32 v54, v54, v55
    v_lshlrev_b32 v56, 16, v52
    v_and_b32 v57, 0xffff0000, v52
    v_lshlrev_b32 v58, 16, v54
    v_and_b32 v59, 0xffff0000, v54
    v_mul_f32 v56, v56, v58
    v_mul_f32 v57, v57, v59
    v_cvt_pk_bf16_f32 v50, v56, v57
    v_accvgpr_read_b32 v60, a90
    v_accvgpr_read_b32 v61, a91
    v_accvgpr_read_b32 v62, a122
    v_accvgpr_read_b32 v63, a123
    v_cvt_pk_bf16_f32 v60, v60, v61
    v_cvt_pk_bf16_f32 v62, v62, v63
    v_lshlrev_b32 v64, 16, v60
    v_and_b32 v65, 0xffff0000, v60
    v_lshlrev_b32 v66, 16, v62
    v_and_b32 v67, 0xffff0000, v62
    v_mul_f32 v64, v64, v66
    v_mul_f32 v65, v65, v67
    v_cvt_pk_bf16_f32 v51, v64, v65
    ds_write_b64 v10, v[50:51] offset:32
    v_accvgpr_read_b32 v52, a92
    v_accvgpr_read_b32 v53, a93
    v_accvgpr_read_b32 v54, a124
    v_accvgpr_read_b32 v55, a125
    v_cvt_pk_bf16_f32 v52, v52, v53
    v_cvt_pk_bf16_f32 v54, v54, v55
    v_lshlrev_b32 v56, 16, v52
    v_and_b32 v57, 0xffff0000, v52
    v_lshlrev_b32 v58, 16, v54
    v_and_b32 v59, 0xffff0000, v54
    v_mul_f32 v56, v56, v58
    v_mul_f32 v57, v57, v59
    v_cvt_pk_bf16_f32 v50, v56, v57
    v_accvgpr_read_b32 v60, a94
    v_accvgpr_read_b32 v61, a95
    v_accvgpr_read_b32 v62, a126
    v_accvgpr_read_b32 v63, a127
    v_cvt_pk_bf16_f32 v60, v60, v61
    v_cvt_pk_bf16_f32 v62, v62, v63
    v_lshlrev_b32 v64, 16, v60
    v_and_b32 v65, 0xffff0000, v60
    v_lshlrev_b32 v66, 16, v62
    v_and_b32 v67, 0xffff0000, v62
    v_mul_f32 v64, v64, v66
    v_mul_f32 v65, v65, v67
    v_cvt_pk_bf16_f32 v51, v64, v65
    ds_write_b64 v10, v[50:51] offset:48
    s_waitcnt lgkmcnt(0)
    ds_read_b128 v[76:79], v11 offset:0
    ds_read_b128 v[80:83], v11 offset:1280
    s_waitcnt lgkmcnt(0)
    s_mov_b32 s81, 18432
    buffer_store_dwordx4 v[76:79], v48, s[72:75], s81 offen sc1
    s_nop 0
    s_mov_b32 s81, 19456
    buffer_store_dwordx4 v[80:83], v48, s[72:75], s81 offen sc1
    v_mov_b32 v14, 152192
GB_43:
    ds_read_b32 v15, v14
    s_waitcnt lgkmcnt(0)
    v_readfirstlane_b32 s84, v15
    s_nop 0
    s_cmp_ge_u32 s84, 68
    s_cbranch_scc0 GB_43
    s_mov_b32 s64, s40
    s_mov_b32 s65, s41
    s_mov_b32 s66, 1605632
    s_mov_b32 s67, 0x00020000
    s_mul_i32 s89, s3, 24576
    s_add_u32 s89, s89, 0
    v_lshrrev_b32 v2, 3, v1
    v_and_b32 v3, 7, v1
    v_lshrrev_b32 v4, 1, v3
    v_bfe_u32 v5, v1, 4, 1
    v_lshlrev_b32 v5, 1, v5
    v_xor_b32 v4, v4, v5
    v_and_b32 v3, 1, v3
    v_lshl_add_u32 v4, v4, 1, v3
    v_lshlrev_b32 v4, 4, v4
    v_mul_u32_u24 v2, 896, v2
    v_add_u32 v12, v2, v4
    s_lshr_b32 s80, s3, 1
    s_mul_i32 s80, s80, 802816
    s_and_b32 s81, s3, 1
    s_mul_i32 s81, s81, 28672
    s_add_u32 s80, s80, s81
    s_lshl_b32 s81, s88, 7
    s_add_u32 s80, s80, s81
    v_add_u32 v12, s80, v12
    s_lshr_b32 s80, s87, 1
    s_mul_i32 s80, s80, 14
    s_lshr_b32 s81, s3, 1
    s_mul_i32 s81, s81, 7
    s_add_u32 s80, s80, s81
    s_lshl_b32 s80, s80, 15
    s_and_b32 s81, s3, 1
    s_lshl_b32 s81, s81, 13
    s_add_u32 s80, s80, s81
    s_and_b32 s81, s87, 1
    s_lshl_b32 s81, s81, 12
    s_add_u32 s80, s80, s81
    v_lshrrev_b32 v2, 2, v1
    v_lshlrev_b32 v2, 6, v2
    v_and_b32 v3, 3, v1
    v_bfe_u32 v4, v1, 4, 2
    v_xor_b32 v3, v3, v4
    v_lshl_add_u32 v13, v3, 4, v2
    v_add_u32 v13, s80, v13
    v_cmp_le_u32 vcc, 14, v1
    s_nop 0
    s_mov_b64 s[90:91], vcc
    v_add_u32 v80, 65536, v84
    s_lshl_b32 s80, s88, 5
    s_add_u32 s80, s80, 512
    v_add_u32 v81, s80, v1
    v_lshlrev_b32 v81, 7, v81
    v_cmp_le_u32 vcc, 32, v1
    s_nop 0
    s_mov_b64 s[92:93], vcc
    s_add_u32 m0, s89, 4096
    s_mov_b32 s80, 0
    buffer_load_dwordx4 v12, s[64:67], s80 offen lds
    s_add_u32 m0, s89, 5120
    s_mov_b32 s80, 7168
    buffer_load_dwordx4 v12, s[64:67], s80 offen lds
    s_add_u32 m0, s89, 6144
    s_mov_b32 s80, 14336
    buffer_load_dwordx4 v12, s[64:67], s80 offen lds
    s_add_u32 m0, s89, 7168
    s_mov_b32 s80, 21504
    buffer_load_dwordx4 v12, s[64:67], s80 offen lds
    s_add_u32 m0, s89, 12288
    s_mov_b32 s80, 114688
    buffer_load_dwordx4 v12, s[64:67], s80 offen lds
    s_add_u32 m0, s89, 13312
    s_mov_b32 s80, 121856
    buffer_load_dwordx4 v12, s[64:67], s80 offen lds
    s_add_u32 m0, s89, 14336
    s_mov_b32 s80, 129024
    buffer_load_dwordx4 v12, s[64:67], s80 offen lds
    s_add_u32 m0, s89, 15360
    s_mov_b32 s80, 136192
    buffer_load_dwordx4 v12, s[64:67], s80 offen lds
    s_add_u32 m0, s89, 20480
    s_mov_b32 s80, 229376
    buffer_load_dwordx4 v12, s[64:67], s80 offen lds
    s_add_u32 m0, s89, 21504
    s_mov_b32 s80, 236544
    buffer_load_dwordx4 v12, s[64:67], s80 offen lds
    s_add_u32 m0, s89, 22528
    s_mov_b32 s80, 243712
    buffer_load_dwordx4 v12, s[64:67], s80 offen lds
    s_add_u32 m0, s89, 23552
    s_mov_b32 s80, 250880
    buffer_load_dwordx4 v12, s[64:67], s80 offen lds
    s_waitcnt vmcnt(16)
    v_cmp_eq_u32 vcc, s12, v86
    v_cmp_eq_u32 s[82:83], s13, v87
    s_nop 0
    s_and_b64 vcc, vcc, s[82:83]
    s_or_b64 vcc, vcc, s[90:91]
    s_cmp_eq_u64 vcc, -1
    s_cbranch_scc1 FC_44
FB_45:
    buffer_load_dwordx2 v[82:83], v84, s[8:11], 0 offen sc0 sc1
    s_waitcnt vmcnt(0)
    v_cmp_eq_u32 vcc, s12, v82
    v_cmp_eq_u32 s[82:83], s13, v83
    s_nop 0
    s_and_b64 vcc, vcc, s[82:83]
    s_or_b64 vcc, vcc, s[90:91]
    s_cmp_eq_u64 vcc, -1
    s_cbranch_scc1 FB_45_ok
    s_sleep 1
    s_branch FB_45
FB_45_ok:
FC_44:
    s_add_u32 m0, s89, 0
    s_mov_b32 s80, 0
    buffer_load_dwordx4 v13, s[72:75], s80 offen sc1 lds
    s_add_u32 m0, s89, 1024
    s_mov_b32 s80, 1024
    buffer_load_dwordx4 v13, s[72:75], s80 offen sc1 lds
    s_add_u32 m0, s89, 2048
    s_mov_b32 s80, 2048
    buffer_load_dwordx4 v13, s[72:75], s80 offen sc1 lds
    s_add_u32 m0, s89, 3072
    s_mov_b32 s80, 3072
    buffer_load_dwordx4 v13, s[72:75], s80 offen sc1 lds
    s_add_u32 m0, s89, 8192
    s_mov_b32 s80, 32768
    buffer_load_dwordx4 v13, s[72:75], s80 offen sc1 lds
    s_add_u32 m0, s89, 9216
    s_mov_b32 s80, 33792
    buffer_load_dwordx4 v13, s[72:75], s80 offen sc1 lds
    s_add_u32 m0, s89, 10240
    s_mov_b32 s80, 34816
    buffer_load_dwordx4 v13, s[72:75], s80 offen sc1 lds
    s_add_u32 m0, s89, 11264
    s_mov_b32 s80, 35840
    buffer_load_dwordx4 v13, s[72:75], s80 offen sc1 lds
    s_add_u32 m0, s89, 16384
    s_mov_b32 s80, 65536
    buffer_load_dwordx4 v13, s[72:75], s80 offen sc1 lds
    s_add_u32 m0, s89, 17408
    s_mov_b32 s80, 66560
    buffer_load_dwordx4 v13, s[72:75], s80 offen sc1 lds
    s_add_u32 m0, s89, 18432
    s_mov_b32 s80, 67584
    buffer_load_dwordx4 v13, s[72:75], s80 offen sc1 lds
    s_add_u32 m0, s89, 19456
    s_mov_b32 s80, 68608
    buffer_load_dwordx4 v13, s[72:75], s80 offen sc1 lds
    v_and_b32 v2, 31, v1
    v_lshrrev_b32 v3, 5, v1
    v_bfe_u32 v8, v1, 2, 2
    v_xor_b32 v9, v3, v8
    v_xor_b32 v10, 2, v9
    v_lshlrev_b32 v2, 6, v2
    v_lshl_add_u32 v4, v9, 4, v2
    v_lshl_add_u32 v5, v10, 4, v2
    v_add_u32 v4, s89, v4
    v_add_u32 v5, s89, v5
    v_lshrrev_b32 v2, 4, v1
    v_and_b32 v3, 15, v1
    v_lshrrev_b32 v8, 2, v3
    v_and_b32 v3, 3, v3
    v_lshrrev_b32 v9, 1, v2
    v_and_b32 v2, 1, v2
    v_lshl_add_u32 v9, v9, 3, v8
    v_lshlrev_b32 v9, 7, v9
    v_lshl_add_u32 v9, v3, 3, v9
    v_lshl_add_u32 v9, v2, 5, v9
    v_lshrrev_b32 v8, 1, v8
    v_lshl_add_u32 v6, v8, 6, v9
    v_xor_b32 v8, 1, v8
    v_lshl_add_u32 v7, v8, 6, v9
    v_add_u32 v6, s89, v6
    v_add_u32 v7, s89, v7
    s_mov_b32 s76, s42
    s_mov_b32 s77, s43
    s_mov_b32 s78, 1835008
    s_mov_b32 s79, 0x00020000
    s_add_u32 s68, s46, 12582912
    s_addc_u32 s69, s47, 0
    s_mov_b32 s70, 1835008
    s_mov_b32 s71, 0x00020000
    v_lshrrev_b32 v2, 2, v0
    v_and_b32 v3, 3, v0
    s_lshl_b32 s80, s87, 6
    v_add_u32 v8, s80, v2
    v_mul_u32_u24 v8, 896, v8
    v_lshl_add_u32 v8, v3, 5, v8
    s_lshl_b32 s80, s88, 7
    v_add_u32 v88, s80, v8
    s_lshl_b32 s80, s88, 6
    s_lshl_b32 s81, s3, 4
    s_add_u32 s80, s80, s81
    v_lshrrev_b32 v8, 3, v1
    v_add_u32 v8, s80, v8
    v_lshlrev_b32 v8, 12, v8
    v_and_b32 v9, 7, v1
    v_lshl_add_u32 v8, v9, 4, v8
    s_lshl_b32 s80, s87, 7
    v_add_u32 v89, s80, v8
    v_accvgpr_write_b32 a0, 0
    v_accvgpr_write_b32 a1, 0
    v_accvgpr_write_b32 a2, 0
    v_accvgpr_write_b32 a3, 0
    v_accvgpr_write_b32 a4, 0
    v_accvgpr_write_b32 a5, 0
    v_accvgpr_write_b32 a6, 0
    v_accvgpr_write_b32 a7, 0
    v_accvgpr_write_b32 a8, 0
    v_accvgpr_write_b32 a9, 0
    v_accvgpr_write_b32 a10, 0
    v_accvgpr_write_b32 a11, 0
    v_accvgpr_write_b32 a12, 0
    v_accvgpr_write_b32 a13, 0
    v_accvgpr_write_b32 a14, 0
    v_accvgpr_write_b32 a15, 0
    v_accvgpr_write_b32 a16, 0
    v_accvgpr_write_b32 a17, 0
    v_accvgpr_write_b32 a18, 0
    v_accvgpr_write_b32 a19, 0
    v_accvgpr_write_b32 a20, 0
    v_accvgpr_write_b32 a21, 0
    v_accvgpr_write_b32 a22, 0
    v_accvgpr_write_b32 a23, 0
    v_accvgpr_write_b32 a24, 0
    v_accvgpr_write_b32 a25, 0
    v_accvgpr_write_b32 a26, 0
    v_accvgpr_write_b32 a27, 0
    v_accvgpr_write_b32 a28, 0
    v_accvgpr_write_b32 a29, 0
    v_accvgpr_write_b32 a30, 0
    v_accvgpr_write_b32 a31, 0
    v_accvgpr_write_b32 a32, 0
    v_accvgpr_write_b32 a33, 0
    v_accvgpr_write_b32 a34, 0
    v_accvgpr_write_b32 a35, 0
    v_accvgpr_write_b32 a36, 0
    v_accvgpr_write_b32 a37, 0
    v_accvgpr_write_b32 a38, 0
    v_accvgpr_write_b32 a39, 0
    v_accvgpr_write_b32 a40, 0
    v_accvgpr_write_b32 a41, 0
    v_accvgpr_write_b32 a42, 0
    v_accvgpr_write_b32 a43, 0
    v_accvgpr_write_b32 a44, 0
    v_accvgpr_write_b32 a45, 0
    v_accvgpr_write_b32 a46, 0
    v_accvgpr_write_b32 a47, 0
    v_accvgpr_write_b32 a48, 0
    v_accvgpr_write_b32 a49, 0
    v_accvgpr_write_b32 a50, 0
    v_accvgpr_write_b32 a51, 0
    v_accvgpr_write_b32 a52, 0
    v_accvgpr_write_b32 a53, 0
    v_accvgpr_write_b32 a54, 0
    v_accvgpr_write_b32 a55, 0
    v_accvgpr_write_b32 a56, 0
    v_accvgpr_write_b32 a57, 0
    v_accvgpr_write_b32 a58, 0
    v_accvgpr_write_b32 a59, 0
    v_accvgpr_write_b32 a60, 0
    v_accvgpr_write_b32 a61, 0
    v_accvgpr_write_b32 a62, 0
    v_accvgpr_write_b32 a63, 0
    s_waitcnt vmcnt(24)
    v_mov_b32 v14, 152260
    v_mov_b32 v15, 1
    s_mov_b64 exec, 1
    ds_add_rtn_u32 v15, v14, v15
    s_mov_b64 exec, -1
    s_waitcnt lgkmcnt(0)
    v_readfirstlane_b32 s84, v15
    s_nop 0
    s_cmp_lg_u32 s84, 3
    s_cbranch_scc1 HS_46
    s_add_u32 s82, s2, 768
    s_lshl_b32 s82, s82, 7
    v_mov_b32 v14, s82
    v_mov_b32 v64, s12
    v_mov_b32 v65, s13
    s_mov_b64 exec, 1
    buffer_store_dwordx2 v[64:65], v14, s[8:11], 0 offen sc0 sc1
    s_mov_b64 exec, -1
HS_46:
    s_waitcnt vmcnt(8)
    ds_read_b64_tr_b16 v[16:17], v6 offset:4096
    ds_read_b64_tr_b16 v[18:19], v6 offset:4608
    ds_read_b64_tr_b16 v[20:21], v7 offset:4096
    ds_read_b64_tr_b16 v[22:23], v7 offset:4608
    ds_read_b128 v[24:27], v4 offset:0
    ds_read_b128 v[28:31], v4 offset:2048
    ds_read_b64_tr_b16 v[32:33], v6 offset:6144
    ds_read_b64_tr_b16 v[34:35], v6 offset:6656
    ds_read_b64_tr_b16 v[36:37], v7 offset:6144
    ds_read_b64_tr_b16 v[38:39], v7 offset:6656
    ds_read_b128 v[40:43], v5 offset:0
    ds_read_b128 v[44:47], v5 offset:2048
    s_waitcnt lgkmcnt(0)
    s_waitcnt vmcnt(4)
    v_mfma_f32_32x32x16_bf16 a[0:15], v[16:19], v[24:27], a[0:15]
    ds_read_b64_tr_b16 v[48:49], v6 offset:12288
    ds_read_b64_tr_b16 v[50:51], v6 offset:12800
    ds_read_b64_tr_b16 v[52:53], v7 offset:12288
    v_mfma_f32_32x32x16_bf16 a[16:31], v[16:19], v[28:31], a[16:31]
    ds_read_b64_tr_b16 v[54:55], v7 offset:12800
    ds_read_b128 v[56:59], v4 offset:8192
    v_mfma_f32_32x32x16_bf16 a[32:47], v[20:23], v[24:27], a[32:47]
    ds_read_b128 v[60:63], v4 offset:10240
    ds_read_b64_tr_b16 v[64:65], v6 offset:14336
    ds_read_b64_tr_b16 v[66:67], v6 offset:14848
    v_mfma_f32_32x32x16_bf16 a[48:63], v[20:23], v[28:31], a[48:63]
    ds_read_b64_tr_b16 v[68:69], v7 offset:14336
    ds_read_b64_tr_b16 v[70:71], v7 offset:14848
    v_mfma_f32_32x32x16_bf16 a[0:15], v[32:35], v[40:43], a[0:15]
    ds_read_b128 v[72:75], v5 offset:8192
    ds_read_b128 v[76:79], v5 offset:10240
    s_add_u32 m0, s89, 0
    s_mov_b32 s80, 98304
    buffer_load_dwordx4 v13, s[72:75], s80 offen sc1 lds
    v_mfma_f32_32x32x16_bf16 a[16:31], v[32:35], v[44:47], a[16:31]
    s_add_u32 m0, s89, 4096
    s_mov_b32 s80, 344064
    buffer_load_dwordx4 v12, s[64:67], s80 offen lds
    s_add_u32 m0, s89, 1024
    s_mov_b32 s80, 99328
    buffer_load_dwordx4 v13, s[72:75], s80 offen sc1 lds
    v_mfma_f32_32x32x16_bf16 a[32:47], v[36:39], v[40:43], a[32:47]
    s_add_u32 m0, s89, 5120
    s_mov_b32 s80, 351232
    buffer_load_dwordx4 v12, s[64:67], s80 offen lds
    s_add_u32 m0, s89, 2048
    s_mov_b32 s80, 100352
    buffer_load_dwordx4 v13, s[72:75], s80 offen sc1 lds
    s_add_u32 m0, s89, 6144
    s_mov_b32 s80, 358400
    buffer_load_dwordx4 v12, s[64:67], s80 offen lds
    v_mfma_f32_32x32x16_bf16 a[48:63], v[36:39], v[44:47], a[48:63]
    s_add_u32 m0, s89, 3072
    s_mov_b32 s80, 101376
    buffer_load_dwordx4 v13, s[72:75], s80 offen sc1 lds
    s_add_u32 m0, s89, 7168
    s_mov_b32 s80, 365568
    buffer_load_dwordx4 v12, s[64:67], s80 offen lds
    s_waitcnt lgkmcnt(0)
    s_waitcnt vmcnt(8)
    v_mfma_f32_32x32x16_bf16 a[0:15], v[48:51], v[56:59], a[0:15]
    ds_read_b64_tr_b16 v[16:17], v6 offset:20480
    ds_read_b64_tr_b16 v[18:19], v6 offset:20992
    ds_read_b64_tr_b16 v[20:21], v7 offset:20480
    v_mfma_f32_32x32x16_bf16 a[16:31], v[48:51], v[60:63], a[16:31]
    ds_read_b64_tr_b16 v[22:23], v7 offset:20992
    ds_read_b128 v[24:27], v4 offset:16384
    v_mfma_f32_32x32x16_bf16 a[32:47], v[52:55], v[56:59], a[32:47]
    ds_read_b128 v[28:31], v4 offset:18432
    ds_read_b64_tr_b16 v[32:33], v6 offset:22528
    ds_read_b64_tr_b16 v[34:35], v6 offset:23040
    v_mfma_f32_32x32x16_bf16 a[48:63], v[52:55], v[60:63], a[48:63]
    ds_read_b64_tr_b16 v[36:37], v7 offset:22528
    ds_read_b64_tr_b16 v[38:39], v7 offset:23040
    v_mfma_f32_32x32x16_bf16 a[0:15], v[64:67], v[72:75], a[0:15]
    ds_read_b128 v[40:43], v5 offset:16384
    ds_read_b128 v[44:47], v5 offset:18432
    s_add_u32 m0, s89, 8192
    s_mov_b32 s80, 131072
    buffer_load_dwordx4 v13, s[72:75], s80 offen sc1 lds
    v_mfma_f32_32x32x16_bf16 a[16:31], v[64:67], v[76:79], a[16:31]
    s_add_u32 m0, s89, 12288
    s_mov_b32 s80, 458752
    buffer_load_dwordx4 v12, s[64:67], s80 offen lds
    s_add_u32 m0, s89, 9216
    s_mov_b32 s80, 132096
    buffer_load_dwordx4 v13, s[72:75], s80 offen sc1 lds
    v_mfma_f32_32x32x16_bf16 a[32:47], v[68:71], v[72:75], a[32:47]
    s_add_u32 m0, s89, 13312
    s_mov_b32 s80, 465920
    buffer_load_dwordx4 v12, s[64:67], s80 offen lds
    s_add_u32 m0, s89, 10240
    s_mov_b32 s80, 133120
    buffer_load_dwordx4 v13, s[72:75], s80 offen sc1 lds
    s_add_u32 m0, s89, 14336
    s_mov_b32 s80, 473088
    buffer_load_dwordx4 v12, s[64:67], s80 offen lds
    v_mfma_f32_32x32x16_bf16 a[48:63], v[68:71], v[76:79], a[48:63]
    s_add_u32 m0, s89, 11264
    s_mov_b32 s80, 134144
    buffer_load_dwordx4 v13, s[72:75], s80 offen sc1 lds
    s_add_u32 m0, s89, 15360
    s_mov_b32 s80, 480256
    buffer_load_dwordx4 v12, s[64:67], s80 offen lds
    s_waitcnt lgkmcnt(0)
    s_waitcnt vmcnt(8)
    buffer_load_dwordx2 v[90:91], v80, s[8:11], 0 offen sc0 sc1
    v_mfma_f32_32x32x16_bf16 a[0:15], v[16:19], v[24:27], a[0:15]
    ds_read_b64_tr_b16 v[48:49], v6 offset:4096
    ds_read_b64_tr_b16 v[50:51], v6 offset:4608
    ds_read_b64_tr_b16 v[52:53], v7 offset:4096
    v_mfma_f32_32x32x16_bf16 a[16:31], v[16:19], v[28:31], a[16:31]
    ds_read_b64_tr_b16 v[54:55], v7 offset:4608
    ds_read_b128 v[56:59], v4 offset:0
    v_mfma_f32_32x32x16_bf16 a[32:47], v[20:23], v[24:27], a[32:47]
    ds_read_b128 v[60:63], v4 offset:2048
    ds_read_b64_tr_b16 v[64:65], v6 offset:6144
    ds_read_b64_tr_b16 v[66:67], v6 offset:6656
    v_mfma_f32_32x32x16_bf16 a[48:63], v[20:23], v[28:31], a[48:63]
    ds_read_b64_tr_b16 v[68:69], v7 offset:6144
    ds_read_b64_tr_b16 v[70:71], v7 offset:6656
    v_mfma_f32_32x32x16_bf16 a[0:15], v[32:35], v[40:43], a[0:15]
    ds_read_b128 v[72:75], v5 offset:0
    ds_read_b128 v[76:79], v5 offset:2048
    s_add_u32 m0, s89, 16384
    s_mov_b32 s80, 163840
    buffer_load_dwordx4 v13, s[72:75], s80 offen sc1 lds
    v_mfma_f32_32x32x16_bf16 a[16:31], v[32:35], v[44:47], a[16:31]
    s_add_u32 m0, s89, 20480
    s_mov_b32 s80, 573440
    buffer_load_dwordx4 v12, s[64:67], s80 offen lds
    s_add_u32 m0, s89, 17408
    s_mov_b32 s80, 164864
    buffer_load_dwordx4 v13, s[72:75], s80 offen sc1 lds
    v_mfma_f32_32x32x16_bf16 a[32:47], v[36:39], v[40:43], a[32:47]
    s_add_u32 m0, s89, 21504
    s_mov_b32 s80, 580608
    buffer_load_dwordx4 v12, s[64:67], s80 offen lds
    s_add_u32 m0, s89, 18432
    s_mov_b32 s80, 165888
    buffer_load_dwordx4 v13, s[72:75], s80 offen sc1 lds
    s_add_u32 m0, s89, 22528
    s_mov_b32 s80, 587776
    buffer_load_dwordx4 v12, s[64:67], s80 offen lds
    v_mfma_f32_32x32x16_bf16 a[48:63], v[36:39], v[44:47], a[48:63]
    s_add_u32 m0, s89, 19456
    s_mov_b32 s80, 166912
    buffer_load_dwordx4 v13, s[72:75], s80 offen sc1 lds
    s_add_u32 m0, s89, 23552
    s_mov_b32 s80, 594944
    buffer_load_dwordx4 v12, s[64:67], s80 offen lds
    s_waitcnt lgkmcnt(0)
    s_waitcnt vmcnt(9)
    v_mfma_f32_32x32x16_bf16 a[0:15], v[48:51], v[56:59], a[0:15]
    ds_read_b64_tr_b16 v[16:17], v6 offset:12288
    ds_read_b64_tr_b16 v[18:19], v6 offset:12800
    ds_read_b64_tr_b16 v[20:21], v7 offset:12288
    v_mfma_f32_32x32x16_bf16 a[16:31], v[48:51], v[60:63], a[16:31]
    ds_read_b64_tr_b16 v[22:23], v7 offset:12800
    ds_read_b128 v[24:27], v4 offset:8192
    v_mfma_f32_32x32x16_bf16 a[32:47], v[52:55], v[56:59], a[32:47]
    ds_read_b128 v[28:31], v4 offset:10240
    ds_read_b64_tr_b16 v[32:33], v6 offset:14336
    ds_read_b64_tr_b16 v[34:35], v6 offset:14848
    v_mfma_f32_32x32x16_bf16 a[48:63], v[52:55], v[60:63], a[48:63]
    ds_read_b64_tr_b16 v[36:37], v7 offset:14336
    ds_read_b64_tr_b16 v[38:39], v7 offset:14848
    v_mfma_f32_32x32x16_bf16 a[0:15], v[64:67], v[72:75], a[0:15]
    ds_read_b128 v[40:43], v5 offset:8192
    ds_read_b128 v[44:47], v5 offset:10240
    s_add_u32 m0, s89, 0
    s_mov_b32 s80, 196608
    buffer_load_dwordx4 v13, s[72:75], s80 offen sc1 lds
    v_mfma_f32_32x32x16_bf16 a[16:31], v[64:67], v[76:79], a[16:31]
    s_add_u32 m0, s89, 4096
    s_mov_b32 s80, 688128
    buffer_load_dwordx4 v12, s[64:67], s80 offen lds
    s_add_u32 m0, s89, 1024
    s_mov_b32 s80, 197632
    buffer_load_dwordx4 v13, s[72:75], s80 offen sc1 lds
    v_mfma_f32_32x32x16_bf16 a[32:47], v[68:71], v[72:75], a[32:47]
    s_add_u32 m0, s89, 5120
    s_mov_b32 s80, 695296
    buffer_load_dwordx4 v12, s[64:67], s80 offen lds
    s_add_u32 m0, s89, 2048
    s_mov_b32 s80, 198656
    buffer_load_dwordx4 v13, s[72:75], s80 offen sc1 lds
    s_add_u32 m0, s89, 6144
    s_mov_b32 s80, 702464
    buffer_load_dwordx4 v12, s[64:67], s80 offen lds
    v_mfma_f32_32x32x16_bf16 a[48:63], v[68:71], v[76:79], a[48:63]
    s_add_u32 m0, s89, 3072
    s_mov_b32 s80, 199680
    buffer_load_dwordx4 v13, s[72:75], s80 offen sc1 lds
    s_add_u32 m0, s89, 7168
    s_mov_b32 s80, 709632
    buffer_load_dwordx4 v12, s[64:67], s80 offen lds
    s_waitcnt lgkmcnt(0)
    s_waitcnt vmcnt(8)
    v_cmp_eq_u32 vcc, s12, v90
    v_cmp_eq_u32 s[82:83], s13, v91
    s_nop 0
    s_and_b64 vcc, vcc, s[82:83]
    s_or_b64 vcc, vcc, s[90:91]
    s_cmp_eq_u64 vcc, -1
    s_cbranch_scc1 FC_47
FB_48:
    buffer_load_dwordx2 v[82:83], v80, s[8:11], 0 offen sc0 sc1
    s_waitcnt vmcnt(0)
    v_cmp_eq_u32 vcc, s12, v82
    v_cmp_eq_u32 s[82:83], s13, v83
    s_nop 0
    s_and_b64 vcc, vcc, s[82:83]
    s_or_b64 vcc, vcc, s[90:91]
    s_cmp_eq_u64 vcc, -1
    s_cbranch_scc1 FB_48_ok
    s_sleep 1
    s_branch FB_48
FB_48_ok:
FC_47:
    v_mfma_f32_32x32x16_bf16 a[0:15], v[16:19], v[24:27], a[0:15]
    ds_read_b64_tr_b16 v[48:49], v6 offset:20480
    ds_read_b64_tr_b16 v[50:51], v6 offset:20992
    ds_read_b64_tr_b16 v[52:53], v7 offset:20480
    v_mfma_f32_32x32x16_bf16 a[16:31], v[16:19], v[28:31], a[16:31]
    ds_read_b64_tr_b16 v[54:55], v7 offset:20992
    ds_read_b128 v[56:59], v4 offset:16384
    v_mfma_f32_32x32x16_bf16 a[32:47], v[20:23], v[24:27], a[32:47]
    ds_read_b128 v[60:63], v4 offset:18432
    ds_read_b64_tr_b16 v[64:65], v6 offset:22528
    ds_read_b64_tr_b16 v[66:67], v6 offset:23040
    v_mfma_f32_32x32x16_bf16 a[48:63], v[20:23], v[28:31], a[48:63]
    ds_read_b64_tr_b16 v[68:69], v7 offset:22528
    ds_read_b64_tr_b16 v[70:71], v7 offset:23040
    v_mfma_f32_32x32x16_bf16 a[0:15], v[32:35], v[40:43], a[0:15]
    ds_read_b128 v[72:75], v5 offset:16384
    ds_read_b128 v[76:79], v5 offset:18432
    s_add_u32 m0, s89, 8192
    s_mov_b32 s80, 16384
    buffer_load_dwordx4 v13, s[72:75], s80 offen sc1 lds
    v_mfma_f32_32x32x16_bf16 a[16:31], v[32:35], v[44:47], a[16:31]
    s_add_u32 m0, s89, 12288
    s_mov_b32 s80, 57344
    buffer_load_dwordx4 v12, s[64:67], s80 offen lds
    s_add_u32 m0, s89, 9216
    s_mov_b32 s80, 17408
    buffer_load_dwordx4 v13, s[72:75], s80 offen sc1 lds
    v_mfma_f32_32x32x16_bf16 a[32:47], v[36:39], v[40:43], a[32:47]
    s_add_u32 m0, s89, 13312
    s_mov_b32 s80, 64512
    buffer_load_dwordx4 v12, s[64:67], s80 offen lds
    s_add_u32 m0, s89, 10240
    s_mov_b32 s80, 18432
    buffer_load_dwordx4 v13, s[72:75], s80 offen sc1 lds
    s_add_u32 m0, s89, 14336
    s_mov_b32 s80, 71680
    buffer_load_dwordx4 v12, s[64:67], s80 offen lds
    v_mfma_f32_32x32x16_bf16 a[48:63], v[36:39], v[44:47], a[48:63]
    s_add_u32 m0, s89, 11264
    s_mov_b32 s80, 19456
    buffer_load_dwordx4 v13, s[72:75], s80 offen sc1 lds
    s_add_u32 m0, s89, 15360
    s_mov_b32 s80, 78848
    buffer_load_dwordx4 v12, s[64:67], s80 offen lds
    s_waitcnt lgkmcnt(0)
    s_waitcnt vmcnt(8)
    v_mfma_f32_32x32x16_bf16 a[0:15], v[48:51], v[56:59], a[0:15]
    ds_read_b64_tr_b16 v[16:17], v6 offset:4096
    ds_read_b64_tr_b16 v[18:19], v6 offset:4608
    ds_read_b64_tr_b16 v[20:21], v7 offset:4096
    v_mfma_f32_32x32x16_bf16 a[16:31], v[48:51], v[60:63], a[16:31]
    ds_read_b64_tr_b16 v[22:23], v7 offset:4608
    ds_read_b128 v[24:27], v4 offset:0
    v_mfma_f32_32x32x16_bf16 a[32:47], v[52:55], v[56:59], a[32:47]
    ds_read_b128 v[28:31], v4 offset:2048
    ds_read_b64_tr_b16 v[32:33], v6 offset:6144
    ds_read_b64_tr_b16 v[34:35], v6 offset:6656
    v_mfma_f32_32x32x16_bf16 a[48:63], v[52:55], v[60:63], a[48:63]
    ds_read_b64_tr_b16 v[36:37], v7 offset:6144
    ds_read_b64_tr_b16 v[38:39], v7 offset:6656
    v_mfma_f32_32x32x16_bf16 a[0:15], v[64:67], v[72:75], a[0:15]
    ds_read_b128 v[40:43], v5 offset:0
    ds_read_b128 v[44:47], v5 offset:2048
    s_add_u32 m0, s89, 16384
    s_mov_b32 s80, 49152
    buffer_load_dwordx4 v13, s[72:75], s80 offen sc1 lds
    v_mfma_f32_32x32x16_bf16 a[16:31], v[64:67], v[76:79], a[16:31]
    s_add_u32 m0, s89, 20480
    s_mov_b32 s80, 172032
    buffer_load_dwordx4 v12, s[64:67], s80 offen lds
    s_add_u32 m0, s89, 17408
    s_mov_b32 s80, 50176
    buffer_load_dwordx4 v13, s[72:75], s80 offen sc1 lds
    v_mfma_f32_32x32x16_bf16 a[32:47], v[68:71], v[72:75], a[32:47]
    s_add_u32 m0, s89, 21504
    s_mov_b32 s80, 179200
    buffer_load_dwordx4 v12, s[64:67], s80 offen lds
    s_add_u32 m0, s89, 18432
    s_mov_b32 s80, 51200
    buffer_load_dwordx4 v13, s[72:75], s80 offen sc1 lds
    s_add_u32 m0, s89, 22528
    s_mov_b32 s80, 186368
    buffer_load_dwordx4 v12, s[64:67], s80 offen lds
    v_mfma_f32_32x32x16_bf16 a[48:63], v[68:71], v[76:79], a[48:63]
    s_add_u32 m0, s89, 19456
    s_mov_b32 s80, 52224
    buffer_load_dwordx4 v13, s[72:75], s80 offen sc1 lds
    s_add_u32 m0, s89, 23552
    s_mov_b32 s80, 193536
    buffer_load_dwordx4 v12, s[64:67], s80 offen lds
    s_waitcnt lgkmcnt(0)
    s_waitcnt vmcnt(8)
    v_mfma_f32_32x32x16_bf16 a[0:15], v[16:19], v[24:27], a[0:15]
    ds_read_b64_tr_b16 v[48:49], v6 offset:12288
    ds_read_b64_tr_b16 v[50:51], v6 offset:12800
    ds_read_b64_tr_b16 v[52:53], v7 offset:12288
    v_mfma_f32_32x32x16_bf16 a[16:31], v[16:19], v[28:31], a[16:31]
    ds_read_b64_tr_b16 v[54:55], v7 offset:12800
    ds_read_b128 v[56:59], v4 offset:8192
    v_mfma_f32_32x32x16_bf16 a[32:47], v[20:23], v[24:27], a[32:47]
    ds_read_b128 v[60:63], v4 offset:10240
    ds_read_b64_tr_b16 v[64:65], v6 offset:14336
    ds_read_b64_tr_b16 v[66:67], v6 offset:14848
    v_mfma_f32_32x32x16_bf16 a[48:63], v[20:23], v[28:31], a[48:63]
    ds_read_b64_tr_b16 v[68:69], v7 offset:14336
    ds_read_b64_tr_b16 v[70:71], v7 offset:14848
    v_mfma_f32_32x32x16_bf16 a[0:15], v[32:35], v[40:43], a[0:15]
    ds_read_b128 v[72:75], v5 offset:8192
    ds_read_b128 v[76:79], v5 offset:10240
    s_add_u32 m0, s89, 0
    s_mov_b32 s80, 81920
    buffer_load_dwordx4 v13, s[72:75], s80 offen sc1 lds
    v_mfma_f32_32x32x16_bf16 a[16:31], v[32:35], v[44:47], a[16:31]
    s_add_u32 m0, s89, 4096
    s_mov_b32 s80, 286720
    buffer_load_dwordx4 v12, s[64:67], s80 offen lds
    s_add_u32 m0, s89, 1024
    s_mov_b32 s80, 82944
    buffer_load_dwordx4 v13, s[72:75], s80 offen sc1 lds
    v_mfma_f32_32x32x16_bf16 a[32:47], v[36:39], v[40:43], a[32:47]
    s_add_u32 m0, s89, 5120
    s_mov_b32 s80, 293888
    buffer_load_dwordx4 v12, s[64:67], s80 offen lds
    s_add_u32 m0, s89, 2048
    s_mov_b32 s80, 83968
    buffer_load_dwordx4 v13, s[72:75], s80 offen sc1 lds
    s_add_u32 m0, s89, 6144
    s_mov_b32 s80, 301056
    buffer_load_dwordx4 v12, s[64:67], s80 offen lds
    v_mfma_f32_32x32x16_bf16 a[48:63], v[36:39], v[44:47], a[48:63]
    s_add_u32 m0, s89, 3072
    s_mov_b32 s80, 84992
    buffer_load_dwordx4 v13, s[72:75], s80 offen sc1 lds
    s_add_u32 m0, s89, 7168
    s_mov_b32 s80, 308224
    buffer_load_dwordx4 v12, s[64:67], s80 offen lds
    s_waitcnt lgkmcnt(0)
    s_waitcnt vmcnt(8)
    v_mfma_f32_32x32x16_bf16 a[0:15], v[48:51], v[56:59], a[0:15]
    ds_read_b64_tr_b16 v[16:17], v6 offset:20480
    ds_read_b64_tr_b16 v[18:19], v6 offset:20992
    ds_read_b64_tr_b16 v[20:21], v7 offset:20480
    v_mfma_f32_32x32x16_bf16 a[16:31], v[48:51], v[60:63], a[16:31]
    ds_read_b64_tr_b16 v[22:23], v7 offset:20992
    ds_read_b128 v[24:27], v4 offset:16384
    v_mfma_f32_32x32x16_bf16 a[32:47], v[52:55], v[56:59], a[32:47]
    ds_read_b128 v[28:31], v4 offset:18432
    ds_read_b64_tr_b16 v[32:33], v6 offset:22528
    ds_read_b64_tr_b16 v[34:35], v6 offset:23040
    v_mfma_f32_32x32x16_bf16 a[48:63], v[52:55], v[60:63], a[48:63]
    ds_read_b64_tr_b16 v[36:37], v7 offset:22528
    ds_read_b64_tr_b16 v[38:39], v7 offset:23040
    v_mfma_f32_32x32x16_bf16 a[0:15], v[64:67], v[72:75], a[0:15]
    ds_read_b128 v[40:43], v5 offset:16384
    ds_read_b128 v[44:47], v5 offset:18432
    s_add_u32 m0, s89, 8192
    s_mov_b32 s80, 114688
    buffer_load_dwordx4 v13, s[72:75], s80 offen sc1 lds
    v_mfma_f32_32x32x16_bf16 a[16:31], v[64:67], v[76:79], a[16:31]
    s_add_u32 m0, s89, 12288
    s_mov_b32 s80, 401408
    buffer_load_dwordx4 v12, s[64:67], s80 offen lds
    s_add_u32 m0, s89, 9216
    s_mov_b32 s80, 115712
    buffer_load_dwordx4 v13, s[72:75], s80 offen sc1 lds
    v_mfma_f32_32x32x16_bf16 a[32:47], v[68:71], v[72:75], a[32:47]
    s_add_u32 m0, s89, 13312
    s_mov_b32 s80, 408576
    buffer_load_dwordx4 v12, s[64:67], s80 offen lds
    s_add_u32 m0, s89, 10240
    s_mov_b32 s80, 116736
    buffer_load_dwordx4 v13, s[72:75], s80 offen sc1 lds
    s_add_u32 m0, s89, 14336
    s_mov_b32 s80, 415744
    buffer_load_dwordx4 v12, s[64:67], s80 offen lds
    v_mfma_f32_32x32x16_bf16 a[48:63], v[68:71], v[76:79], a[48:63]
    s_add_u32 m0, s89, 11264
    s_mov_b32 s80, 117760
    buffer_load_dwordx4 v13, s[72:75], s80 offen sc1 lds
    s_add_u32 m0, s89, 15360
    s_mov_b32 s80, 422912
    buffer_load_dwordx4 v12, s[64:67], s80 offen lds
    s_waitcnt lgkmcnt(0)
    s_waitcnt vmcnt(8)
    v_mfma_f32_32x32x16_bf16 a[0:15], v[16:19], v[24:27], a[0:15]
    ds_read_b64_tr_b16 v[48:49], v6 offset:4096
    ds_read_b64_tr_b16 v[50:51], v6 offset:4608
    ds_read_b64_tr_b16 v[52:53], v7 offset:4096
    v_mfma_f32_32x32x16_bf16 a[16:31], v[16:19], v[28:31], a[16:31]
    ds_read_b64_tr_b16 v[54:55], v7 offset:4608
    ds_read_b128 v[56:59], v4 offset:0
    v_mfma_f32_32x32x16_bf16 a[32:47], v[20:23], v[24:27], a[32:47]
    ds_read_b128 v[60:63], v4 offset:2048
    ds_read_b64_tr_b16 v[64:65], v6 offset:6144
    ds_read_b64_tr_b16 v[66:67], v6 offset:6656
    v_mfma_f32_32x32x16_bf16 a[48:63], v[20:23], v[28:31], a[48:63]
    ds_read_b64_tr_b16 v[68:69], v7 offset:6144
    ds_read_b64_tr_b16 v[70:71], v7 offset:6656
    v_mfma_f32_32x32x16_bf16 a[0:15], v[32:35], v[40:43], a[0:15]
    ds_read_b128 v[72:75], v5 offset:0
    ds_read_b128 v[76:79], v5 offset:2048
    s_add_u32 m0, s89, 16384
    s_mov_b32 s80, 147456
    buffer_load_dwordx4 v13, s[72:75], s80 offen sc1 lds
    v_mfma_f32_32x32x16_bf16 a[16:31], v[32:35], v[44:47], a[16:31]
    s_add_u32 m0, s89, 20480
    s_mov_b32 s80, 516096
    buffer_load_dwordx4 v12, s[64:67], s80 offen lds
    s_add_u32 m0, s89, 17408
    s_mov_b32 s80, 148480
    buffer_load_dwordx4 v13, s[72:75], s80 offen sc1 lds
    v_mfma_f32_32x32x16_bf16 a[32:47], v[36:39], v[40:43], a[32:47]
    s_add_u32 m0, s89, 21504
    s_mov_b32 s80, 523264
    buffer_load_dwordx4 v12, s[64:67], s80 offen lds
    s_add_u32 m0, s89, 18432
    s_mov_b32 s80, 149504
    buffer_load_dwordx4 v13, s[72:75], s80 offen sc1 lds
    s_add_u32 m0, s89, 22528
    s_mov_b32 s80, 530432
    buffer_load_dwordx4 v12, s[64:67], s80 offen lds
    v_mfma_f32_32x32x16_bf16 a[48:63], v[36:39], v[44:47], a[48:63]
    s_add_u32 m0, s89, 19456
    s_mov_b32 s80, 150528
    buffer_load_dwordx4 v13, s[72:75], s80 offen sc1 lds
    s_add_u32 m0, s89, 23552
    s_mov_b32 s80, 537600
    buffer_load_dwordx4 v12, s[64:67], s80 offen lds
    s_waitcnt lgkmcnt(0)
    s_waitcnt vmcnt(8)
    buffer_load_dwordx2 v[86:87], v81, s[8:11], 0 offen sc0 sc1
    buffer_load_dwordx4 v[96:99], v88, s[48:51], 0 offen
    buffer_load_dwordx4 v[100:103], v88, s[48:51], 0 offen offset:16
    v_mfma_f32_32x32x16_bf16 a[0:15], v[48:51], v[56:59], a[0:15]
    ds_read_b64_tr_b16 v[16:17], v6 offset:12288
    ds_read_b64_tr_b16 v[18:19], v6 offset:12800
    ds_read_b64_tr_b16 v[20:21], v7 offset:12288
    v_mfma_f32_32x32x16_bf16 a[16:31], v[48:51], v[60:63], a[16:31]
    ds_read_b64_tr_b16 v[22:23], v7 offset:12800
    ds_read_b128 v[24:27], v4 offset:8192
    v_mfma_f32_32x32x16_bf16 a[32:47], v[52:55], v[56:59], a[32:47]
    ds_read_b128 v[28:31], v4 offset:10240
    ds_read_b64_tr_b16 v[32:33], v6 offset:14336
    ds_read_b64_tr_b16 v[34:35], v6 offset:14848
    v_mfma_f32_32x32x16_bf16 a[48:63], v[52:55], v[60:63], a[48:63]
    ds_read_b64_tr_b16 v[36:37], v7 offset:14336
    ds_read_b64_tr_b16 v[38:39], v7 offset:14848
    v_mfma_f32_32x32x16_bf16 a[0:15], v[64:67], v[72:75], a[0:15]
    ds_read_b128 v[40:43], v5 offset:8192
    ds_read_b128 v[44:47], v5 offset:10240
    s_add_u32 m0, s89, 0
    s_mov_b32 s80, 180224
    buffer_load_dwordx4 v13, s[72:75], s80 offen sc1 lds
    v_mfma_f32_32x32x16_bf16 a[16:31], v[64:67], v[76:79], a[16:31]
    s_add_u32 m0, s89, 4096
    s_mov_b32 s80, 630784
    buffer_load_dwordx4 v12, s[64:67], s80 offen lds
    s_add_u32 m0, s89, 1024
    s_mov_b32 s80, 181248
    buffer_load_dwordx4 v13, s[72:75], s80 offen sc1 lds
    v_mfma_f32_32x32x16_bf16 a[32:47], v[68:71], v[72:75], a[32:47]
    s_add_u32 m0, s89, 5120
    s_mov_b32 s80, 637952
    buffer_load_dwordx4 v12, s[64:67], s80 offen lds
    s_add_u32 m0, s89, 2048
    s_mov_b32 s80, 182272
    buffer_load_dwordx4 v13, s[72:75], s80 offen sc1 lds
    s_add_u32 m0, s89, 6144
    s_mov_b32 s80, 645120
    buffer_load_dwordx4 v12, s[64:67], s80 offen lds
    v_mfma_f32_32x32x16_bf16 a[48:63], v[68:71], v[76:79], a[48:63]
    s_add_u32 m0, s89, 3072
    s_mov_b32 s80, 183296
    buffer_load_dwordx4 v13, s[72:75], s80 offen sc1 lds
    s_add_u32 m0, s89, 7168
    s_mov_b32 s80, 652288
    buffer_load_dwordx4 v12, s[64:67], s80 offen lds
    s_waitcnt lgkmcnt(0)
    s_waitcnt vmcnt(11)
    v_mfma_f32_32x32x16_bf16 a[0:15], v[16:19], v[24:27], a[0:15]
    ds_read_b64_tr_b16 v[48:49], v6 offset:20480
    ds_read_b64_tr_b16 v[50:51], v6 offset:20992
    ds_read_b64_tr_b16 v[52:53], v7 offset:20480
    v_mfma_f32_32x32x16_bf16 a[16:31], v[16:19], v[28:31], a[16:31]
    ds_read_b64_tr_b16 v[54:55], v7 offset:20992
    ds_read_b128 v[56:59], v4 offset:16384
    v_mfma_f32_32x32x16_bf16 a[32:47], v[20:23], v[24:27], a[32:47]
    ds_read_b128 v[60:63], v4 offset:18432
    ds_read_b64_tr_b16 v[64:65], v6 offset:22528
    ds_read_b64_tr_b16 v[66:67], v6 offset:23040
    v_mfma_f32_32x32x16_bf16 a[48:63], v[20:23], v[28:31], a[48:63]
    ds_read_b64_tr_b16 v[68:69], v7 offset:22528
    ds_read_b64_tr_b16 v[70:71], v7 offset:23040
    v_mfma_f32_32x32x16_bf16 a[0:15], v[32:35], v[40:43], a[0:15]
    ds_read_b128 v[72:75], v5 offset:16384
    ds_read_b128 v[76:79], v5 offset:18432
    s_add_u32 m0, s89, 8192
    s_mov_b32 s80, 212992
    buffer_load_dwordx4 v13, s[72:75], s80 offen sc1 lds
    v_mfma_f32_32x32x16_bf16 a[16:31], v[32:35], v[44:47], a[16:31]
    s_add_u32 m0, s89, 12288
    s_mov_b32 s80, 745472
    buffer_load_dwordx4 v12, s[64:67], s80 offen lds
    s_add_u32 m0, s89, 9216
    s_mov_b32 s80, 214016
    buffer_load_dwordx4 v13, s[72:75], s80 offen sc1 lds
    v_mfma_f32_32x32x16_bf16 a[32:47], v[36:39], v[40:43], a[32:47]
    s_add_u32 m0, s89, 13312
    s_mov_b32 s80, 752640
    buffer_load_dwordx4 v12, s[64:67], s80 offen lds
    s_add_u32 m0, s89, 10240
    s_mov_b32 s80, 215040
    buffer_load_dwordx4 v13, s[72:75], s80 offen sc1 lds
    s_add_u32 m0, s89, 14336
    s_mov_b32 s80, 759808
    buffer_load_dwordx4 v12, s[64:67], s80 offen lds
    v_mfma_f32_32x32x16_bf16 a[48:63], v[36:39], v[44:47], a[48:63]
    s_add_u32 m0, s89, 11264
    s_mov_b32 s80, 216064
    buffer_load_dwordx4 v13, s[72:75], s80 offen sc1 lds
    s_add_u32 m0, s89, 15360
    s_mov_b32 s80, 766976
    buffer_load_dwordx4 v12, s[64:67], s80 offen lds
    s_waitcnt lgkmcnt(0)
    s_waitcnt vmcnt(8)
    v_mfma_f32_32x32x16_bf16 a[0:15], v[48:51], v[56:59], a[0:15]
    ds_read_b64_tr_b16 v[16:17], v6 offset:4096
    ds_read_b64_tr_b16 v[18:19], v6 offset:4608
    v_mfma_f32_32x32x16_bf16 a[16:31], v[48:51], v[60:63], a[16:31]
    ds_read_b64_tr_b16 v[20:21], v7 offset:4096
    v_mfma_f32_32x32x16_bf16 a[32:47], v[52:55], v[56:59], a[32:47]
    ds_read_b64_tr_b16 v[22:23], v7 offset:4608
    ds_read_b128 v[24:27], v4 offset:0
    v_mfma_f32_32x32x16_bf16 a[48:63], v[52:55], v[60:63], a[48:63]
    ds_read_b128 v[28:31], v4 offset:2048
    v_mfma_f32_32x32x16_bf16 a[0:15], v[64:67], v[72:75], a[0:15]
    ds_read_b64_tr_b16 v[32:33], v6 offset:6144
    ds_read_b64_tr_b16 v[34:35], v6 offset:6656
    v_mfma_f32_32x32x16_bf16 a[16:31], v[64:67], v[76:79], a[16:31]
    ds_read_b64_tr_b16 v[36:37], v7 offset:6144
    v_mfma_f32_32x32x16_bf16 a[32:47], v[68:71], v[72:75], a[32:47]
    ds_read_b64_tr_b16 v[38:39], v7 offset:6656
    ds_read_b128 v[40:43], v5 offset:0
    v_mfma_f32_32x32x16_bf16 a[48:63], v[68:71], v[76:79], a[48:63]
    ds_read_b128 v[44:47], v5 offset:2048
    s_waitcnt lgkmcnt(0)
    s_waitcnt vmcnt(0)
    v_cmp_eq_u32 vcc, s12, v86
    v_cmp_eq_u32 s[82:83], s13, v87
    s_nop 0
    s_and_b64 vcc, vcc, s[82:83]
    s_or_b64 vcc, vcc, s[92:93]
    s_cmp_eq_u64 vcc, -1
    s_cbranch_scc1 FC_49
FB_50:
    buffer_load_dwordx2 v[82:83], v81, s[8:11], 0 offen sc0 sc1
    s_waitcnt vmcnt(0)
    v_cmp_eq_u32 vcc, s12, v82
    v_cmp_eq_u32 s[82:83], s13, v83
    s_nop 0
    s_and_b64 vcc, vcc, s[82:83]
    s_or_b64 vcc, vcc, s[92:93]
    s_cmp_eq_u64 vcc, -1
    s_cbranch_scc1 FB_50_ok
    s_sleep 1
    s_branch FB_50
FB_50_ok:
FC_49:
    buffer_load_dwordx4 v[104:107], v89, s[68:71], 0 offen sc1
    s_mov_b32 s80, 32768
    buffer_load_dwordx4 v[108:111], v89, s[68:71], s80 offen sc1
    v_mfma_f32_32x32x16_bf16 a[0:15], v[16:19], v[24:27], a[0:15]
    ds_read_b64_tr_b16 v[48:49], v6 offset:12288
    ds_read_b64_tr_b16 v[50:51], v6 offset:12800
    v_mfma_f32_32x32x16_bf16 a[16:31], v[16:19], v[28:31], a[16:31]
    ds_read_b64_tr_b16 v[52:53], v7 offset:12288
    v_mfma_f32_32x32x16_bf16 a[32:47], v[20:23], v[24:27], a[32:47]
    ds_read_b64_tr_b16 v[54:55], v7 offset:12800
    ds_read_b128 v[56:59], v4 offset:8192
    v_mfma_f32_32x32x16_bf16 a[48:63], v[20:23], v[28:31], a[48:63]
    ds_read_b128 v[60:63], v4 offset:10240
    v_mfma_f32_32x32x16_bf16 a[0:15], v[32:35], v[40:43], a[0:15]
    ds_read_b64_tr_b16 v[64:65], v6 offset:14336
    ds_read_b64_tr_b16 v[66:67], v6 offset:14848
    v_mfma_f32_32x32x16_bf16 a[16:31], v[32:35], v[44:47], a[16:31]
    ds_read_b64_tr_b16 v[68:69], v7 offset:14336
    v_mfma_f32_32x32x16_bf16 a[32:47], v[36:39], v[40:43], a[32:47]
    ds_read_b64_tr_b16 v[70:71], v7 offset:14848
    ds_read_b128 v[72:75], v5 offset:8192
    v_mfma_f32_32x32x16_bf16 a[48:63], v[36:39], v[44:47], a[48:63]
    ds_read_b128 v[76:79], v5 offset:10240
    s_waitcnt lgkmcnt(0)
    v_mfma_f32_32x32x16_bf16 a[0:15], v[48:51], v[56:59], a[0:15]
    v_mfma_f32_32x32x16_bf16 a[16:31], v[48:51], v[60:63], a[16:31]
    v_mfma_f32_32x32x16_bf16 a[32:47], v[52:55], v[56:59], a[32:47]
    v_mfma_f32_32x32x16_bf16 a[48:63], v[52:55], v[60:63], a[48:63]
    v_mfma_f32_32x32x16_bf16 a[0:15], v[64:67], v[72:75], a[0:15]
    v_mfma_f32_32x32x16_bf16 a[16:31], v[64:67], v[76:79], a[16:31]
    v_mfma_f32_32x32x16_bf16 a[32:47], v[68:71], v[72:75], a[32:47]
    v_mfma_f32_32x32x16_bf16 a[48:63], v[68:71], v[76:79], a[48:63]
    v_and_b32 v2, 31, v1
    v_mul_u32_u24 v2, 272, v2
    v_lshrrev_b32 v3, 5, v1
    v_lshl_add_u32 v2, v3, 4, v2
    v_add_u32 v2, s89, v2
    v_lshlrev_b32 v7, 4, v1
    v_add_u32 v7, s89, v7
    s_nop 1
    ds_write_b128 v2, a[0:3] offset:0
    ds_write_b128 v2, a[4:7] offset:32
    ds_write_b128 v2, a[8:11] offset:64
    ds_write_b128 v2, a[12:15] offset:96
    ds_write_b128 v2, a[16:19] offset:8704
    ds_write_b128 v2, a[20:23] offset:8736
    ds_write_b128 v2, a[24:27] offset:8768
    ds_write_b128 v2, a[28:31] offset:8800
    ds_write_b128 v2, a[32:35] offset:128
    ds_write_b128 v2, a[36:39] offset:160
    ds_write_b128 v2, a[40:43] offset:192
    ds_write_b128 v2, a[44:47] offset:224
    ds_write_b128 v2, a[48:51] offset:8832
    ds_write_b128 v2, a[52:55] offset:8864
    ds_write_b128 v2, a[56:59] offset:8896
    ds_write_b128 v2, a[60:63] offset:8928
    s_waitcnt vmcnt(0)
    ds_write_b128 v7, v[104:107] offset:17408
    ds_write_b128 v7, v[108:111] offset:18432
    s_waitcnt lgkmcnt(0)
    v_mov_b32 v6, 152192
    v_mov_b32 v7, 1
    s_mov_b64 exec, 1
    ds_add_u32 v6, v7
    s_mov_b64 exec, -1
SYNC_51:
    ds_read_b32 v7, v6
    s_waitcnt lgkmcnt(0)
    v_readfirstlane_b32 s84, v7
    s_nop 0
    s_cmp_ge_u32 s84, 72
    s_cbranch_scc0 SYNC_51
    v_lshrrev_b32 v3, 2, v0
    v_and_b32 v4, 3, v0
    v_mul_u32_u24 v6, 272, v3
    v_lshl_add_u32 v6, v4, 6, v6
    v_add_u32 v6, 0, v6
    v_mul_u32_u24 v7, 24576, v4
    v_lshl_add_u32 v7, v3, 1, v7
    v_add_u32 v7, 17408, v7
    v_add_u32 v24, 49152, v6
    ds_read_b128 v[32:35], v6 offset:0
    ds_read_b128 v[36:39], v6 offset:16
    ds_read_b128 v[40:43], v6 offset:32
    ds_read_b128 v[44:47], v6 offset:48
    ds_read_b128 v[48:51], v6 offset:24576
    ds_read_b128 v[52:55], v6 offset:24592
    ds_read_b128 v[56:59], v6 offset:24608
    ds_read_b128 v[60:63], v6 offset:24624
    ds_read_b128 v[64:67], v24 offset:0
    ds_read_b128 v[68:71], v24 offset:16
    ds_read_b128 v[72:75], v24 offset:32
    ds_read_b128 v[76:79], v24 offset:48
    ds_read_b128 v[80:83], v24 offset:24576
    ds_read_b128 v[84:87], v24 offset:24592
    ds_read_b128 v[112:115], v24 offset:24608
    ds_read_b128 v[116:119], v24 offset:24624
    ds_read_u16 v8, v7 offset:0
    ds_read_u16 v9, v7 offset:128
    ds_read_u16 v10, v7 offset:256
    ds_read_u16 v11, v7 offset:384
    ds_read_u16 v12, v7 offset:512
    ds_read_u16 v13, v7 offset:640
    ds_read_u16 v14, v7 offset:768
    ds_read_u16 v15, v7 offset:896
    ds_read_u16 v16, v7 offset:1024
    ds_read_u16 v17, v7 offset:1152
    ds_read_u16 v18, v7 offset:1280
    ds_read_u16 v19, v7 offset:1408
    ds_read_u16 v20, v7 offset:1536
    ds_read_u16 v21, v7 offset:1664
    ds_read_u16 v22, v7 offset:1792
    ds_read_u16 v23, v7 offset:1920
    s_waitcnt lgkmcnt(0)
    v_add_f32 v32, v32, v48
    v_add_f32 v64, v64, v80
    v_add_f32 v33, v33, v49
    v_add_f32 v65, v65, v81
    v_add_f32 v34, v34, v50
    v_add_f32 v66, v66, v82
    v_add_f32 v35, v35, v51
    v_add_f32 v67, v67, v83
    v_add_f32 v36, v36, v52
    v_add_f32 v68, v68, v84
    v_add_f32 v37, v37, v53
    v_add_f32 v69, v69, v85
    v_add_f32 v38, v38, v54
    v_add_f32 v70, v70, v86
    v_add_f32 v39, v39, v55
    v_add_f32 v71, v71, v87
    v_add_f32 v40, v40, v56
    v_add_f32 v72, v72, v112
    v_add_f32 v41, v41, v57
    v_add_f32 v73, v73, v113
    v_add_f32 v42, v42, v58
    v_add_f32 v74, v74, v114
    v_add_f32 v43, v43, v59
    v_add_f32 v75, v75, v115
    v_add_f32 v44, v44, v60
    v_add_f32 v76, v76, v116
    v_add_f32 v45, v45, v61
    v_add_f32 v77, v77, v117
    v_add_f32 v46, v46, v62
    v_add_f32 v78, v78, v118
    v_add_f32 v47, v47, v63
    v_add_f32 v79, v79, v119
    v_add_f32 v32, v32, v64
    v_add_f32 v33, v33, v65
    v_add_f32 v34, v34, v66
    v_add_f32 v35, v35, v67
    v_add_f32 v36, v36, v68
    v_add_f32 v37, v37, v69
    v_add_f32 v38, v38, v70
    v_add_f32 v39, v39, v71
    v_add_f32 v40, v40, v72
    v_add_f32 v41, v41, v73
    v_add_f32 v42, v42, v74
    v_add_f32 v43, v43, v75
    v_add_f32 v44, v44, v76
    v_add_f32 v45, v45, v77
    v_add_f32 v46, v46, v78
    v_add_f32 v47, v47, v79
    v_cvt_pk_bf16_f32 v32, v32, v33
    v_lshlrev_b32 v48, 16, v96
    v_and_b32 v49, 0xffff0000, v96
    v_lshlrev_b32 v8, 16, v8
    v_lshlrev_b32 v9, 16, v9
    v_add_f32 v48, v48, v8
    v_add_f32 v49, v49, v9
    v_cvt_pk_bf16_f32 v48, v48, v49
    v_lshlrev_b32 v64, 16, v48
    v_and_b32 v65, 0xffff0000, v48
    v_and_b32 v33, 0xffff0000, v32
    v_lshlrev_b32 v32, 16, v32
    v_add_f32 v64, v64, v32
    v_add_f32 v65, v65, v33
    v_cvt_pk_bf16_f32 v120, v64, v65
    v_cvt_pk_bf16_f32 v34, v34, v35
    v_lshlrev_b32 v50, 16, v97
    v_and_b32 v51, 0xffff0000, v97
    v_lshlrev_b32 v10, 16, v10
    v_lshlrev_b32 v11, 16, v11
    v_add_f32 v50, v50, v10
    v_add_f32 v51, v51, v11
    v_cvt_pk_bf16_f32 v50, v50, v51
    v_lshlrev_b32 v66, 16, v50
    v_and_b32 v67, 0xffff0000, v50
    v_and_b32 v35, 0xffff0000, v34
    v_lshlrev_b32 v34, 16, v34
    v_add_f32 v66, v66, v34
    v_add_f32 v67, v67, v35
    v_cvt_pk_bf16_f32 v121, v66, v67
    v_cvt_pk_bf16_f32 v36, v36, v37
    v_lshlrev_b32 v52, 16, v98
    v_and_b32 v53, 0xffff0000, v98
    v_lshlrev_b32 v12, 16, v12
    v_lshlrev_b32 v13, 16, v13
    v_add_f32 v52, v52, v12
    v_add_f32 v53, v53, v13
    v_cvt_pk_bf16_f32 v52, v52, v53
    v_lshlrev_b32 v68, 16, v52
    v_and_b32 v69, 0xffff0000, v52
    v_and_b32 v37, 0xffff0000, v36
    v_lshlrev_b32 v36, 16, v36
    v_add_f32 v68, v68, v36
    v_add_f32 v69, v69, v37
    v_cvt_pk_bf16_f32 v122, v68, v69
    v_cvt_pk_bf16_f32 v38, v38, v39
    v_lshlrev_b32 v54, 16, v99
    v_and_b32 v55, 0xffff0000, v99
    v_lshlrev_b32 v14, 16, v14
    v_lshlrev_b32 v15, 16, v15
    v_add_f32 v54, v54, v14
    v_add_f32 v55, v55, v15
    v_cvt_pk_bf16_f32 v54, v54, v55
    v_lshlrev_b32 v70, 16, v54
    v_and_b32 v71, 0xffff0000, v54
    v_and_b32 v39, 0xffff0000, v38
    v_lshlrev_b32 v38, 16, v38
    v_add_f32 v70, v70, v38
    v_add_f32 v71, v71, v39
    v_cvt_pk_bf16_f32 v123, v70, v71
    v_cvt_pk_bf16_f32 v40, v40, v41
    v_lshlrev_b32 v56, 16, v100
    v_and_b32 v57, 0xffff0000, v100
    v_lshlrev_b32 v16, 16, v16
    v_lshlrev_b32 v17, 16, v17
    v_add_f32 v56, v56, v16
    v_add_f32 v57, v57, v17
    v_cvt_pk_bf16_f32 v56, v56, v57
    v_lshlrev_b32 v72, 16, v56
    v_and_b32 v73, 0xffff0000, v56
    v_and_b32 v41, 0xffff0000, v40
    v_lshlrev_b32 v40, 16, v40
    v_add_f32 v72, v72, v40
    v_add_f32 v73, v73, v41
    v_cvt_pk_bf16_f32 v124, v72, v73
    v_cvt_pk_bf16_f32 v42, v42, v43
    v_lshlrev_b32 v58, 16, v101
    v_and_b32 v59, 0xffff0000, v101
    v_lshlrev_b32 v18, 16, v18
    v_lshlrev_b32 v19, 16, v19
    v_add_f32 v58, v58, v18
    v_add_f32 v59, v59, v19
    v_cvt_pk_bf16_f32 v58, v58, v59
    v_lshlrev_b32 v74, 16, v58
    v_and_b32 v75, 0xffff0000, v58
    v_and_b32 v43, 0xffff0000, v42
    v_lshlrev_b32 v42, 16, v42
    v_add_f32 v74, v74, v42
    v_add_f32 v75, v75, v43
    v_cvt_pk_bf16_f32 v125, v74, v75
    v_cvt_pk_bf16_f32 v44, v44, v45
    v_lshlrev_b32 v60, 16, v102
    v_and_b32 v61, 0xffff0000, v102
    v_lshlrev_b32 v20, 16, v20
    v_lshlrev_b32 v21, 16, v21
    v_add_f32 v60, v60, v20
    v_add_f32 v61, v61, v21
    v_cvt_pk_bf16_f32 v60, v60, v61
    v_lshlrev_b32 v76, 16, v60
    v_and_b32 v77, 0xffff0000, v60
    v_and_b32 v45, 0xffff0000, v44
    v_lshlrev_b32 v44, 16, v44
    v_add_f32 v76, v76, v44
    v_add_f32 v77, v77, v45
    v_cvt_pk_bf16_f32 v126, v76, v77
    v_cvt_pk_bf16_f32 v46, v46, v47
    v_lshlrev_b32 v62, 16, v103
    v_and_b32 v63, 0xffff0000, v103
    v_lshlrev_b32 v22, 16, v22
    v_lshlrev_b32 v23, 16, v23
    v_add_f32 v62, v62, v22
    v_add_f32 v63, v63, v23
    v_cvt_pk_bf16_f32 v62, v62, v63
    v_lshlrev_b32 v78, 16, v62
    v_and_b32 v79, 0xffff0000, v62
    v_and_b32 v47, 0xffff0000, v46
    v_lshlrev_b32 v46, 16, v46
    v_add_f32 v78, v78, v46
    v_add_f32 v79, v79, v47
    v_cvt_pk_bf16_f32 v127, v78, v79
    buffer_store_dwordx4 v[120:123], v88, s[76:79], 0 offen
    buffer_store_dwordx4 v[124:127], v88, s[76:79], 0 offen offset:16
L_END:
    s_endpgm
L_CODE_END:
.section .rodata,"a"
.p2align 6
.amdhsa_kernel parallel_sum__ssm_conv_s4__glu_gated_bilinear__prompt_kernel
  .amdhsa_next_free_vgpr 256
  .amdhsa_next_free_sgpr 102
  .amdhsa_accum_offset 128
  .amdhsa_group_segment_fixed_size 0
  .amdhsa_kernarg_size 128
  .amdhsa_user_sgpr_count 2
  .amdhsa_user_sgpr_kernarg_segment_ptr 1
  .amdhsa_system_sgpr_workgroup_id_x 1
.end_amdhsa_kernel
```
